```python
import torch

def _softmax(x, axis=-1):
    return torch.softmax(x, dim=axis)
def _gelu(x):
    return torch.nn.functional.gelu(x, approximate="tanh")
def _silu(x):
    return torch.nn.functional.silu(x)
def _sigmoid(x):
    return torch.sigmoid(x)
def _layernorm(x, axis=-1, eps=1e-5):
    m = x.mean(dim=axis, keepdim=True)
    v = x.var(dim=axis, keepdim=True, unbiased=False)
    return (x - m) / torch.sqrt(v + eps)
def _scatter_add(tgt, idx, src, axis=0):
    return tgt.clone().index_add_(axis, idx, src)
def _segment_sum(src, seg, n):
    out = torch.zeros((n,) + src.shape[1:], dtype=src.dtype)
    return out.index_add_(0, seg, src)
def _pad(x, pw):
    flat = tuple(v for pair in reversed(pw) for v in pair)
    return torch.nn.functional.pad(x, flat)

kernel_name = 'recurrent_scan__sliding_block_cached__glu_gated_swiglu__decode'

def setup_inputs():

    _w = (lambda a: (lambda t: t.to(torch.bfloat16) if t.is_floating_point() else t)(torch.as_tensor(a)))
    def _A_setup():
        B, Sq, D = 1, 1, 640
        Hq, Hkv, Sk, Dh = 32, 32, 32768, 192
        assert Hq % Hkv == 0, (Hq, Hkv)
        return {
            "x": _w((lambda *s: torch.randn(*s, dtype=torch.bfloat16) * 0.05)(B, Sq, D)),
            "k_cache": _w((lambda *s: torch.randn(*s, dtype=torch.bfloat16) * 3.2)(B, Hkv, Sk, Dh)),
            "v_cache": _w((lambda *s: torch.randn(*s, dtype=torch.bfloat16) * 3.2)(B, Hkv, Sk, Dh)),
            "wq": _w((lambda *s: torch.randn(*s, dtype=torch.bfloat16) * 3.2)(D, Hq * Dh) * (D ** -0.5)),
            "wo": _w((lambda *s: torch.randn(*s, dtype=torch.bfloat16) * 3.2)(Hq * Dh, D) * ((Hq * Dh) ** -0.5)),
        }
    _A_in = _A_setup()

    def _B_setup():
        B, S, D, F = 1, 1, 640, 1536
        return {
            "x": _w((lambda *s: torch.randn(*s, dtype=torch.bfloat16) * 0.05)(B, S, D)),
            "w1": _w((lambda *s: torch.randn(*s, dtype=torch.bfloat16) * 0.4)(D, F) * (2.0 / D) ** 0.5),
            "w3": _w((lambda *s: torch.randn(*s, dtype=torch.bfloat16) * 0.4)(D, F) * (2.0 / D) ** 0.5),
            "w2": _w((lambda *s: torch.randn(*s, dtype=torch.bfloat16) * 0.4)(F, D) * (2.0 / F) ** 0.5),
        }
    _B_in = _B_setup()

    return {
        "A_x": _A_in["x"],
        "A_k_cache": _A_in["k_cache"],
        "A_v_cache": _A_in["v_cache"],
        "A_wq": _A_in["wq"],
        "A_wo": _A_in["wo"],
        "B_x": _B_in["x"],
        "B_w1": _B_in["w1"],
        "B_w3": _B_in["w3"],
        "B_w2": _B_in["w2"],
    }

def reference(A_x, A_k_cache, A_v_cache, A_wq, A_wo, B_x, B_w1, B_w3, B_w2):
    def _A_ref(x, k_cache, v_cache, wq, wo):
        B, Sq, D = x.shape
        Hq, Dh = 32, 192
        Hkv, Sk = k_cache.shape[1], k_cache.shape[2]
        W = min(4096, max(256, Sk // 4))
        rep = Hq // Hkv
        q = (lambda x, *d: x.permute(*d))((x @ wq).reshape(B, Sq, Hq, Dh), 0, 2, 1, 3)
        k = (lambda x, n, axis: torch.repeat_interleave(x, n, dim=axis))(k_cache[:, :, Sk - W:, :], rep, axis=1)
        v = (lambda x, n, axis: torch.repeat_interleave(x, n, dim=axis))(v_cache[:, :, Sk - W:, :], rep, axis=1)
        scores = torch.einsum("bhqd,bhkd->bhqk", q, k) * (Dh ** -0.5)
        p = _softmax(scores, axis=-1)
        o = torch.einsum("bhqk,bhkd->bhqd", p, v)
        return (lambda x, *d: x.permute(*d))(o, 0, 2, 1, 3).reshape(B, Sq, Hq * Dh) @ wo

    def _B_ref(x, w1, w3, w2):
        gate = torch.einsum("bsd,df->bsf", x, w1)
        up = torch.einsum("bsd,df->bsf", x, w3)
        h = _silu(gate) * up
        out = torch.einsum("bsf,fd->bsd", h, w2)
        return out

    x = A_x
    xn = _layernorm(x, axis=-1)
    s = _A_ref(xn, A_k_cache, A_v_cache, A_wq, A_wo)
    g = _silu(_B_ref(xn, B_w1, B_w3, B_w2))
    return x + s * g
```

```asm
; @launch grid=(256,1,1) block=(512,1,1) lds=29952
.amdgcn_target "amdgcn-amd-amdhsa--gfx950"
.text
.globl recurrent_scan__sliding_block_cached__glu_gated_swiglu__decode_kernel
.p2align 12
.p2align 8
.type recurrent_scan__sliding_block_cached__glu_gated_swiglu__decode_kernel,@function
recurrent_scan__sliding_block_cached__glu_gated_swiglu__decode_kernel:
    s_load_dwordx2 s[40:41], s[0:1], 8
    s_load_dwordx2 s[44:45], s[0:1], 16
    s_load_dwordx16 s[16:31], s[0:1], 0
    s_load_dwordx8 s[32:39], s[0:1], 64
    v_lshrrev_b32 v1, 6, v0
    s_cmpk_ge_u32 s2, 256
    s_cbranch_scc1 L_end
    v_readfirstlane_b32 s3, v1
    v_and_b32 v0, 63, v0
    v_lshrrev_b32 v2, 3, v0
    v_and_b32 v3, 7, v0
    s_and_b32 s4, s2, 7
    s_lshr_b32 s5, s2, 3
    s_lshr_b32 s6, s2, 7
    s_lshl1_add_u32 s8, s4, s6
    s_and_b32 s9, s5, 15
    s_mov_b32 s42, 402653184
    s_mov_b32 s43, 0x20000
    s_cmp_eq_u32 s3, 7
    s_cbranch_scc1 L_w7
    s_cmp_ge_u32 s3, 4
    s_cbranch_scc1 L_late
    s_cmp_ge_u32 s5, 30
    s_cbranch_scc1 L_ann
    s_mul_i32 s13, s5, 52
    s_lshr_b32 s13, s13, 8
    s_mul_i32 s12, s13, 5
    s_sub_u32 s12, s5, s12
    s_lshl_b32 s12, s12, 8
    s_mul_i32 s10, s4, 6
    s_add_u32 s10, s10, s13
    s_lshr_b32 s10, s10, 1
    s_and_b32 s13, s13, 1
    s_lshl4_add_u32 s10, s10, s13
    s_lshl1_add_u32 s10, s3, s10
    s_mulk_i32 s10, 5120
    s_add_u32 s10, s10, s12
    v_and_b32 v30, 8, v0
    v_lshrrev_b32 v29, 4, v0
    v_lshl_add_u32 v30, v30, 2, v29
    v_mul_u32_u24 v30, 1280, v30
    v_lshl_add_u32 v30, v3, 4, v30
    s_mov_b32 s62, 1966080
    s_mov_b32 s63, s43
    s_lshl_b32 s13, s3, 11
    s_add_u32 m0, s13, 20224
    s_waitcnt lgkmcnt(0)
    s_mov_b64 s[60:61], s[32:33]
    buffer_load_dwordx4 v30, s[60:63], s10 offen nt lds
    s_add_u32 m0, s13, 21120
    s_nop 0
    buffer_load_dwordx4 v30, s[60:63], s10 offen offset:128 nt lds
L_e3:
    s_cmp_eq_u32 s3, 1
    s_cbranch_scc1 L_pad1
    s_cmp_eq_u32 s3, 2
    s_cbranch_scc1 L_pad2
    s_cmp_eq_u32 s3, 3
    s_cbranch_scc1 L_pad3
    s_branch L_e0
L_ann:
    s_sub_u32 s10, s5, s3
    s_cmp_lg_u32 s10, 31
    s_cbranch_scc1 L_e3
    s_setprio 3
    s_getreg_b32 s62, hwreg(HW_REG_XCC_ID, 0, 4)
    s_mul_i32 s13, s4, 4352
    s_add_u32 s13, s13, 802816
    s_lshl_b32 s12, s4, 5
    s_add_u32 s62, s62, 1
    v_lshlrev_b32 v28, 3, v0
    v_mov_b32 v30, 0
    v_mov_b32 v31, 0
    s_mov_b32 s50, 849920
    s_mov_b32 s51, s43
    s_waitcnt lgkmcnt(0)
    s_mov_b64 s[48:49], s[38:39]
    buffer_store_dwordx2 v[30:31], v28, s[48:51], s13 offen
    s_waitcnt vmcnt(0)
    s_atomic_add s62, s[36:37], s12
    s_setprio 0
    s_branch L_e0
L_late:
    v_mov_b32 v31, 0
    v_lshlrev_b32 v30, 2, v3
    ds_write_b32 v30, v31
    s_add_u32 s8, s8, 16
    s_and_b32 s7, s5, 7
    s_bfe_u32 s10, s5, 0x10003
    s_lshl4_add_u32 s6, s6, s10
    s_lshl1_add_u32 s6, s4, s6
    s_sub_u32 s13, s3, 4
    s_mul_i32 s14, s4, 100352
    s_lshl_b32 s71, s5, 7
    s_add_u32 s71, s71, s14
    s_add_u32 s71, s71, 98304
    s_mul_i32 s10, s5, 3072
    s_add_u32 s14, s14, s10
    s_lshl_b32 s70, s13, 10
    s_add_u32 s70, s70, s14
    v_mov_b32 v140, -1
    v_mov_b32 v141, -1
    v_mov_b32 v142, -1
    v_mov_b32 v143, -1
    v_lshlrev_b32 v25, 4, v0
    v_mul_u32_u24 v26, 20, v0
    v_mul_u32_u24 v27, 20, v2
    v_mul_u32_u24 v30, 122880, v2
    v_lshl_add_u32 v30, v3, 4, v30
    s_mul_i32 s10, s7, 160
    s_mul_i32 s11, s7, 983040
    s_mul_i32 s12, s6, 384
    s_lshl_b32 s13, s13, 7
    s_add_u32 s11, s11, s12
    s_add_u32 s11, s11, s13
    s_movk_i32 s12, 12288
    s_mov_b32 s50, 849920
    s_mov_b32 s51, 0x20000
    s_mov_b32 s54, 1280
    s_mov_b32 s55, 0x20000
    s_mov_b32 s58, 7864320
    s_mov_b32 s59, 0x20000
    s_lshl4_add_u32 s60, s3, s5
    s_cmpk_lt_u32 s60, 80
    s_waitcnt lgkmcnt(0)
    s_mov_b64 s[48:49], s[38:39]
    s_mov_b64 s[52:53], s[16:17]
    s_mov_b64 s[56:57], s[22:23]
    buffer_store_dwordx4 v[140:143], v25, s[48:51], s70 offen
    s_cbranch_scc0 L_l1
    s_mov_b64 exec, 0xff
    buffer_store_dwordx4 v[140:143], v25, s[48:51], s71 offen
    s_mov_b64 exec, -1
L_l1:
    buffer_load_dwordx4 v[128:131], v26, s[52:55], 0 offen
    buffer_load_dword v132, v26, s[52:55], 0 offen offset:16
    buffer_load_dwordx4 v[134:137], v27, s[52:55], s10 offen
    buffer_load_dword v138, v27, s[52:55], s10 offen offset:16
    buffer_load_dwordx4 v[32:35], v30, s[56:59], s11 offen nt
    s_add_u32 s11, s11, s12
    buffer_load_dwordx4 v[36:39], v30, s[56:59], s11 offen nt
    s_add_u32 s11, s11, s12
    buffer_load_dwordx4 v[40:43], v30, s[56:59], s11 offen nt
    s_add_u32 s11, s11, s12
    buffer_load_dwordx4 v[44:47], v30, s[56:59], s11 offen nt
    s_add_u32 s11, s11, s12
    buffer_load_dwordx4 v[48:51], v30, s[56:59], s11 offen nt
    s_add_u32 s11, s11, s12
    buffer_load_dwordx4 v[52:55], v30, s[56:59], s11 offen nt
    s_add_u32 s11, s11, s12
    buffer_load_dwordx4 v[56:59], v30, s[56:59], s11 offen nt
    s_add_u32 s11, s11, s12
    buffer_load_dwordx4 v[60:63], v30, s[56:59], s11 offen nt
    s_add_u32 s11, s11, s12
    buffer_load_dwordx4 v[64:67], v30, s[56:59], s11 offen nt
    s_add_u32 s11, s11, s12
    buffer_load_dwordx4 v[68:71], v30, s[56:59], s11 offen nt
    s_cmp_ge_u32 s5, 16
    s_cselect_b64 s[60:61], s[30:31], s[28:29]
    s_mov_b32 s62, 1966080
    s_mov_b32 s63, 0x20000
    v_mul_u32_u24 v30, 30720, v2
    v_lshl_add_u32 v30, v3, 4, v30
    s_mul_i32 s11, s7, 245760
    s_bfe_u32 s10, s5, 0x10003
    s_mul_i32 s12, s10, 15360
    s_add_u32 s11, s11, s12
    s_mul_i32 s12, s4, 384
    s_add_u32 s11, s11, s12
    s_add_u32 s11, s11, s13
    buffer_load_dwordx4 v[72:75], v30, s[60:63], s11 offen offset:0 nt
    buffer_load_dwordx4 v[76:79], v30, s[60:63], s11 offen offset:3072 nt
    s_addk_i32 s11, 6144
    buffer_load_dwordx4 v[80:83], v30, s[60:63], s11 offen offset:0 nt
    buffer_load_dwordx4 v[84:87], v30, s[60:63], s11 offen offset:3072 nt
    s_addk_i32 s11, 6144
    buffer_load_dwordx4 v[88:91], v30, s[60:63], s11 offen offset:0 nt
    v_and_b32 v28, 1, v3
    v_lshlrev_b32 v28, 4, v28
    v_mov_b32 v29, 0xffff
    v_lshlrev_b32 v28, v28, v29
    v_lshrrev_b32 v29, 1, v3
    v_cmp_eq_u32 vcc, 0, v29
    s_nop 1
    v_cndmask_b32 v4, 0, v28, vcc
    v_cmp_eq_u32 vcc, 1, v29
    s_nop 1
    v_cndmask_b32 v5, 0, v28, vcc
    v_cmp_eq_u32 vcc, 2, v29
    s_nop 1
    v_cndmask_b32 v6, 0, v28, vcc
    v_cmp_eq_u32 vcc, 3, v29
    s_nop 1
    v_cndmask_b32 v7, 0, v28, vcc
    v_lshrrev_b32 v28, 4, v0
    v_lshlrev_b32 v28, 7, v28
    v_lshl_add_u32 v247, v3, 4, v28
    s_lshl_b32 s11, s13, 2
    v_add_u32 v24, s11, v247
    s_waitcnt vmcnt(15)
    v_lshlrev_b32 v140, 16, v128
    v_and_b32 v141, 0xffff0000, v128
    v_lshlrev_b32 v142, 16, v129
    v_and_b32 v143, 0xffff0000, v129
    v_lshlrev_b32 v144, 16, v130
    v_and_b32 v145, 0xffff0000, v130
    v_lshlrev_b32 v146, 16, v131
    v_and_b32 v147, 0xffff0000, v131
    v_lshlrev_b32 v148, 16, v132
    v_and_b32 v149, 0xffff0000, v132
    v_add_f32 v160, v140, v141
    v_add_f32 v160, v160, v142
    v_add_f32 v160, v160, v143
    v_add_f32 v160, v160, v144
    v_add_f32 v160, v160, v145
    v_add_f32 v160, v160, v146
    v_add_f32 v160, v160, v147
    v_add_f32 v160, v160, v148
    v_add_f32 v160, v160, v149
    s_nop 1
    v_add_f32_dpp v160, v160, v160 quad_perm:[1,0,3,2] row_mask:0xf bank_mask:0xf
    s_nop 1
    v_add_f32_dpp v160, v160, v160 quad_perm:[2,3,0,1] row_mask:0xf bank_mask:0xf
    s_nop 1
    v_add_f32_dpp v160, v160, v160 row_half_mirror row_mask:0xf bank_mask:0xf
    s_nop 1
    v_add_f32_dpp v160, v160, v160 row_ror:8 row_mask:0xf bank_mask:0xf
    v_mov_b32 v161, v160
    s_nop 1
    v_permlane16_swap_b32 v160, v161
    v_add_f32 v160, v160, v161
    v_mov_b32 v161, v160
    s_nop 1
    v_permlane32_swap_b32 v160, v161
    v_add_f32 v160, v160, v161
    v_mul_f32 v160, 0x3acccccd, v160
    v_sub_f32 v140, v140, v160
    v_sub_f32 v141, v141, v160
    v_sub_f32 v142, v142, v160
    v_sub_f32 v143, v143, v160
    v_sub_f32 v144, v144, v160
    v_sub_f32 v145, v145, v160
    v_sub_f32 v146, v146, v160
    v_sub_f32 v147, v147, v160
    v_sub_f32 v148, v148, v160
    v_sub_f32 v149, v149, v160
    v_mul_f32 v162, v140, v140
    v_fmac_f32 v162, v141, v141
    v_fmac_f32 v162, v142, v142
    v_fmac_f32 v162, v143, v143
    v_fmac_f32 v162, v144, v144
    v_fmac_f32 v162, v145, v145
    v_fmac_f32 v162, v146, v146
    v_fmac_f32 v162, v147, v147
    v_fmac_f32 v162, v148, v148
    v_fmac_f32 v162, v149, v149
    s_nop 1
    v_add_f32_dpp v162, v162, v162 quad_perm:[1,0,3,2] row_mask:0xf bank_mask:0xf
    s_nop 1
    v_add_f32_dpp v162, v162, v162 quad_perm:[2,3,0,1] row_mask:0xf bank_mask:0xf
    s_nop 1
    v_add_f32_dpp v162, v162, v162 row_half_mirror row_mask:0xf bank_mask:0xf
    s_nop 1
    v_add_f32_dpp v162, v162, v162 row_ror:8 row_mask:0xf bank_mask:0xf
    v_mov_b32 v161, v162
    s_nop 1
    v_permlane16_swap_b32 v162, v161
    v_add_f32 v162, v162, v161
    v_mov_b32 v161, v162
    s_nop 1
    v_permlane32_swap_b32 v162, v161
    v_add_f32 v162, v162, v161
    v_mul_f32 v162, 0x3acccccd, v162
    v_cvt_pk_bf16_f32 v162, v160, v162
    v_lshlrev_b32 v160, 16, v162
    v_and_b32 v162, 0xffff0000, v162
    v_add_f32 v162, 0x3727c5ac, v162
    v_cvt_pk_bf16_f32 v162, v162, v162
    v_lshlrev_b32 v162, 16, v162
    v_sqrt_f32 v162, v162
    s_nop 0
    v_cvt_pk_bf16_f32 v162, v162, v162
    v_lshlrev_b32 v162, 16, v162
    v_rcp_f32 v162, v162
    s_waitcnt vmcnt(8)
    s_barrier
    v_lshlrev_b32 v150, 16, v134
    v_and_b32 v151, 0xffff0000, v134
    v_lshlrev_b32 v152, 16, v135
    v_and_b32 v153, 0xffff0000, v135
    v_lshlrev_b32 v154, 16, v136
    v_and_b32 v155, 0xffff0000, v136
    v_lshlrev_b32 v156, 16, v137
    v_and_b32 v157, 0xffff0000, v137
    v_lshlrev_b32 v158, 16, v138
    v_and_b32 v159, 0xffff0000, v138
    v_sub_f32 v150, v150, v160
    v_sub_f32 v151, v151, v160
    v_sub_f32 v152, v152, v160
    v_sub_f32 v153, v153, v160
    v_sub_f32 v154, v154, v160
    v_sub_f32 v155, v155, v160
    v_sub_f32 v156, v156, v160
    v_sub_f32 v157, v157, v160
    v_sub_f32 v158, v158, v160
    v_sub_f32 v159, v159, v160
    v_cvt_pk_bf16_f32 v151, v150, v151
    v_lshlrev_b32 v150, 16, v151
    v_and_b32 v151, 0xffff0000, v151
    v_cvt_pk_bf16_f32 v153, v152, v153
    v_lshlrev_b32 v152, 16, v153
    v_and_b32 v153, 0xffff0000, v153
    v_cvt_pk_bf16_f32 v155, v154, v155
    v_lshlrev_b32 v154, 16, v155
    v_and_b32 v155, 0xffff0000, v155
    v_cvt_pk_bf16_f32 v157, v156, v157
    v_lshlrev_b32 v156, 16, v157
    v_and_b32 v157, 0xffff0000, v157
    v_cvt_pk_bf16_f32 v159, v158, v159
    v_lshlrev_b32 v158, 16, v159
    v_and_b32 v159, 0xffff0000, v159
    v_mul_f32 v150, v150, v162
    v_mul_f32 v151, v151, v162
    v_mul_f32 v152, v152, v162
    v_mul_f32 v153, v153, v162
    v_mul_f32 v154, v154, v162
    v_mul_f32 v155, v155, v162
    v_mul_f32 v156, v156, v162
    v_mul_f32 v157, v157, v162
    v_mul_f32 v158, v158, v162
    v_mul_f32 v159, v159, v162
    v_cvt_pk_bf16_f32 v167, v150, v150
    v_and_b32 v164, v4, v167
    v_and_b32 v165, v5, v167
    v_and_b32 v166, v6, v167
    v_and_b32 v167, v7, v167
    v_cvt_pk_bf16_f32 v171, v151, v151
    v_and_b32 v168, v4, v171
    v_and_b32 v169, v5, v171
    v_and_b32 v170, v6, v171
    v_and_b32 v171, v7, v171
    v_cvt_pk_bf16_f32 v175, v152, v152
    v_and_b32 v172, v4, v175
    v_and_b32 v173, v5, v175
    v_and_b32 v174, v6, v175
    v_and_b32 v175, v7, v175
    v_cvt_pk_bf16_f32 v179, v153, v153
    v_and_b32 v176, v4, v179
    v_and_b32 v177, v5, v179
    v_and_b32 v178, v6, v179
    v_and_b32 v179, v7, v179
    v_cvt_pk_bf16_f32 v183, v154, v154
    v_and_b32 v180, v4, v183
    v_and_b32 v181, v5, v183
    v_and_b32 v182, v6, v183
    v_and_b32 v183, v7, v183
    v_cvt_pk_bf16_f32 v187, v155, v155
    v_and_b32 v184, v4, v187
    v_and_b32 v185, v5, v187
    v_and_b32 v186, v6, v187
    v_and_b32 v187, v7, v187
    v_cvt_pk_bf16_f32 v191, v156, v156
    v_and_b32 v188, v4, v191
    v_and_b32 v189, v5, v191
    v_and_b32 v190, v6, v191
    v_and_b32 v191, v7, v191
    v_cvt_pk_bf16_f32 v195, v157, v157
    v_and_b32 v192, v4, v195
    v_and_b32 v193, v5, v195
    v_and_b32 v194, v6, v195
    v_and_b32 v195, v7, v195
    v_cvt_pk_bf16_f32 v199, v158, v158
    v_and_b32 v196, v4, v199
    v_and_b32 v197, v5, v199
    v_and_b32 v198, v6, v199
    v_and_b32 v199, v7, v199
    v_cvt_pk_bf16_f32 v203, v159, v159
    v_and_b32 v200, v4, v203
    v_and_b32 v201, v5, v203
    v_and_b32 v202, v6, v203
    v_and_b32 v203, v7, v203
    s_waitcnt vmcnt(5)
    v_mfma_f32_16x16x32_bf16 v[224:227], v[164:167], v[32:35], 0
    v_mfma_f32_16x16x32_bf16 v[224:227], v[168:171], v[36:39], v[224:227]
    v_mfma_f32_16x16x32_bf16 v[224:227], v[172:175], v[40:43], v[224:227]
    v_mfma_f32_16x16x32_bf16 v[224:227], v[176:179], v[44:47], v[224:227]
    v_mfma_f32_16x16x32_bf16 v[224:227], v[180:183], v[48:51], v[224:227]
    v_mfma_f32_16x16x32_bf16 v[224:227], v[184:187], v[52:55], v[224:227]
    v_mfma_f32_16x16x32_bf16 v[224:227], v[188:191], v[56:59], v[224:227]
    v_mfma_f32_16x16x32_bf16 v[224:227], v[192:195], v[60:63], v[224:227]
    v_mfma_f32_16x16x32_bf16 v[224:227], v[196:199], v[64:67], v[224:227]
    v_mfma_f32_16x16x32_bf16 v[224:227], v[200:203], v[68:71], v[224:227]
    s_cmp_lg_u32 s10, 0
    s_waitcnt vmcnt(0)
    s_cbranch_scc1 L_mh1
    v_mfma_f32_16x16x32_bf16 v[228:231], v[164:167], v[72:75], 0
    v_mfma_f32_16x16x32_bf16 v[228:231], v[168:171], v[76:79], v[228:231]
    v_mfma_f32_16x16x32_bf16 v[228:231], v[172:175], v[80:83], v[228:231]
    v_mfma_f32_16x16x32_bf16 v[228:231], v[176:179], v[84:87], v[228:231]
    v_mfma_f32_16x16x32_bf16 v[228:231], v[180:183], v[88:91], v[228:231]
    s_branch L_mh2
L_mh1:
    v_mfma_f32_16x16x32_bf16 v[228:231], v[184:187], v[72:75], 0
    v_mfma_f32_16x16x32_bf16 v[228:231], v[188:191], v[76:79], v[228:231]
    v_mfma_f32_16x16x32_bf16 v[228:231], v[192:195], v[80:83], v[228:231]
    v_mfma_f32_16x16x32_bf16 v[228:231], v[196:199], v[84:87], v[228:231]
    v_mfma_f32_16x16x32_bf16 v[228:231], v[200:203], v[88:91], v[228:231]
L_mh2:
    s_nop 7
    v_permlane32_swap_b32 v224, v228
    v_permlane32_swap_b32 v225, v229
    v_permlane32_swap_b32 v226, v230
    v_permlane32_swap_b32 v227, v231
    v_add_f32_dpp v224, v228, v224 row_ror:8 row_mask:0xf bank_mask:0xf
    v_add_f32_dpp v225, v229, v225 row_ror:8 row_mask:0xf bank_mask:0xf
    v_add_f32_dpp v226, v230, v226 row_ror:8 row_mask:0xf bank_mask:0xf
    v_add_f32_dpp v227, v231, v227 row_ror:8 row_mask:0xf bank_mask:0xf
    s_mov_b32 exec_lo, 0x00ff00ff
    s_mov_b32 exec_hi, 0x00ff00ff
    ds_write_b128 v24, v[224:227] offset:28416
    buffer_store_dwordx4 v[224:227], v24, s[48:51], s14 offen
L_lq:
    s_cmp_eq_u32 s3, 4
    s_cbranch_scc1 L_pad4
    s_cmp_eq_u32 s3, 5
    s_cbranch_scc1 L_pad5
    s_cmp_eq_u32 s3, 6
    s_cbranch_scc1 L_pad6
L_lq2:
    s_mov_b64 exec, -1
    s_waitcnt lgkmcnt(0)
    s_barrier
    s_branch L_stream
L_w7:
    s_add_u32 s8, s8, 16
    v_and_b32 v28, 1, v3
    v_lshlrev_b32 v28, 4, v28
    v_mov_b32 v29, 0xffff
    v_lshlrev_b32 v28, v28, v29
    v_lshrrev_b32 v29, 1, v3
    v_cmp_eq_u32 vcc, 0, v29
    s_nop 1
    v_cndmask_b32 v4, 0, v28, vcc
    v_cmp_eq_u32 vcc, 1, v29
    s_nop 1
    v_cndmask_b32 v5, 0, v28, vcc
    v_cmp_eq_u32 vcc, 2, v29
    s_nop 1
    v_cndmask_b32 v6, 0, v28, vcc
    v_cmp_eq_u32 vcc, 3, v29
    s_nop 1
    v_cndmask_b32 v7, 0, v28, vcc
    v_lshrrev_b32 v28, 4, v0
    v_lshlrev_b32 v28, 7, v28
    v_lshl_add_u32 v247, v3, 4, v28
    s_waitcnt lgkmcnt(0)
    s_mov_b64 s[48:49], s[38:39]
    s_mov_b32 s50, 849920
    s_mov_b32 s51, 0x20000
    s_lshl_b32 s12, s4, 5
    v_mov_b32 v31, 0
    s_barrier
    s_load_dword s11, s[36:37], s12
    s_mov_b64 s[64:65], s[36:37]
    s_mov_b32 s66, 256
    s_mov_b32 s67, 0x20000
    s_getreg_b32 s10, hwreg(HW_REG_XCC_ID, 0, 4)
    s_mul_i32 s13, s4, 4352
    s_add_u32 s13, s13, 802816
    s_add_u32 s10, s10, 1
    s_mov_b64 exec, 1
    v_mov_b32 v29, 1
    s_waitcnt lgkmcnt(0)
    s_cmp_lg_u32 s11, 0
    s_cbranch_scc1 L_r1
    s_mov_b32 s15, 200000
Lpoll5:
    buffer_load_dword v28, off, s[64:67], s12 sc1
    s_waitcnt vmcnt(0)
    v_cmp_eq_u32 vcc, 0, v28
    s_cbranch_vccz Lpdone5
    s_sleep 8
    s_sub_u32 s15, s15, 1
    s_cbranch_scc0 Lpoll5
Lpdone5:
    v_readfirstlane_b32 s11, v28
L_r1:
    s_nop 0
    s_cmp_eq_u32 s11, s10
    s_cbranch_scc1 L_r2
    ds_write_b32 v31, v29 offset:0
    s_branch L_r3
L_r2:
    v_mov_b32 v28, 2
    ds_write_b32 v31, v28 offset:0
    s_add_u32 s13, s13, s5
    buffer_store_byte v29, off, s[48:51], s13
L_r3:
    s_cmp_lg_u32 s5, 31
    s_cbranch_scc1 L_lq
    s_mov_b64 exec, -1
    v_mov_b32 v144, 0
    v_mov_b32 v145, 0
    v_mov_b32 v146, 0
    v_mov_b32 v147, 0
    v_lshrrev_b32 v28, 2, v0
    v_lshlrev_b32 v28, 2, v28
    v_add_lshl_u32 v28, v28, v0, 4
    s_mul_i32 s11, s4, 1536
    s_add_u32 s11, s11, 837632
    s_mov_b32 exec_hi, 0xffff
    buffer_store_dwordx4 v[144:147], v28, s[48:51], s11 offen sc1
    s_mov_b32 s6, 1
    s_waitcnt vmcnt(0)
    s_atomic_add s6, s[36:37], 4
    s_branch L_lq
.p2align 12
L_e0:
    v_and_b32 v28, 1, v3
    v_lshlrev_b32 v28, 4, v28
    v_mov_b32 v29, 0xffff
    v_lshlrev_b32 v28, v28, v29
    v_lshrrev_b32 v29, 1, v3
    v_cmp_eq_u32 vcc, 0, v29
    s_nop 1
    v_cndmask_b32 v4, 0, v28, vcc
    v_cmp_eq_u32 vcc, 1, v29
    s_nop 1
    v_cndmask_b32 v5, 0, v28, vcc
    v_cmp_eq_u32 vcc, 2, v29
    s_nop 1
    v_cndmask_b32 v6, 0, v28, vcc
    v_cmp_eq_u32 vcc, 3, v29
    s_nop 1
    v_cndmask_b32 v7, 0, v28, vcc
    v_lshrrev_b32 v28, 4, v0
    v_lshlrev_b32 v28, 7, v28
    v_lshl_add_u32 v247, v3, 4, v28
    s_barrier
L_stream:
    s_and_b32 s11, s3, 3
    s_mul_i32 s8, s8, 12582912
    s_lshl2_add_u32 s11, s9, s11
    s_add_u32 s8, s8, 11010048
    s_mulk_i32 s11, 3072
    v_mul_u32_u24 v1, 384, v2
    s_add_u32 s8, s8, s11
    v_lshl_add_u32 v1, v3, 4, v1
    s_mov_b32 s10, 208896
    s_mov_b64 s[46:47], s[42:43]
    s_waitcnt lgkmcnt(0)
    buffer_load_dwordx4 v[32:35], v1, s[40:43], s8 offen offset:0 nt
    v_mov_b32 v242, 0
    ds_read_b32 v242, v242 offset:12
    buffer_load_dwordx4 v[36:39], v1, s[40:43], s8 offen offset:128 nt
    buffer_load_dwordx4 v[40:43], v1, s[40:43], s8 offen offset:256 nt
    s_cmp_eq_u32 s9, 15
    s_cselect_b32 s11, 12288, s10
    s_add_u32 s18, s8, s11
    buffer_load_dwordx4 v[44:47], v1, s[40:43], s18 offen offset:0 nt
    buffer_load_dwordx4 v[48:51], v1, s[40:43], s18 offen offset:128 nt
    s_mov_b64 s[48:49], s[38:39]
    s_mov_b32 s50, 849920
    s_mov_b32 s51, 0x20000
    s_mul_i32 s13, s4, 4352
    s_add_u32 s13, s13, 802816
    v_lshlrev_b32 v29, 2, v3
    s_waitcnt lgkmcnt(0)
    v_readfirstlane_b32 s12, v242
    s_nop 0
    s_cmp_lg_u32 s12, 2
    s_cselect_b64 vcc, -1, 0
    s_cmp_eq_u32 s12, 1
    s_cbranch_scc0 Lwk5a
    s_waitcnt vmcnt(4)
Lwk5a:
    s_cbranch_vccz Lwk5b
    s_waitcnt vmcnt(5)
Lwk5b:
    buffer_load_dwordx4 v[52:55], v1, s[40:43], s18 offen offset:256 nt
    s_cmp_eq_u32 s9, 14
    s_cselect_b32 s11, 12288, s10
    s_add_u32 s19, s18, s11
    s_cmp_eq_u32 s12, 1
    s_cbranch_scc0 Lwk6a
    s_waitcnt vmcnt(4)
Lwk6a:
    s_cbranch_vccz Lwk6b
    s_waitcnt vmcnt(5)
Lwk6b:
    buffer_load_dwordx4 v[56:59], v1, s[40:43], s19 offen offset:0 nt
    s_cmp_eq_u32 s12, 1
    s_cbranch_scc0 Lwk7a
    s_waitcnt vmcnt(4)
Lwk7a:
    s_cbranch_vccz Lwk7b
    s_waitcnt vmcnt(5)
Lwk7b:
    s_waitcnt vmcnt(6)
    buffer_load_dwordx4 v[60:63], v1, s[40:43], s19 offen offset:128 nt
    v_mov_b32 v242, 0
    ds_read_b32 v242, v242 offset:12
    s_waitcnt lgkmcnt(0)
    v_readfirstlane_b32 s12, v242
    s_nop 0
    s_cmp_lg_u32 s12, 2
    s_cselect_b64 vcc, -1, 0
    s_cmp_eq_u32 s12, 1
    s_cbranch_scc0 Lwk8a
    s_waitcnt vmcnt(4)
Lwk8a:
    s_cbranch_vccz Lwk8b
    s_waitcnt vmcnt(5)
Lwk8b:
    s_waitcnt vmcnt(6)
    buffer_load_dwordx4 v[64:67], v1, s[40:43], s19 offen offset:256 nt
    s_cmp_eq_u32 s9, 13
    s_cselect_b32 s11, 12288, s10
    s_add_u32 s20, s19, s11
    s_cmp_eq_u32 s12, 1
    s_cbranch_scc0 Lwk9a
    s_waitcnt vmcnt(4)
Lwk9a:
    s_cbranch_vccz Lwk9b
    s_waitcnt vmcnt(5)
Lwk9b:
    s_waitcnt vmcnt(6)
    buffer_load_dwordx4 v[68:71], v1, s[40:43], s20 offen offset:0 nt
    s_cmp_eq_u32 s12, 1
    s_cbranch_scc0 Lwk10a
    s_waitcnt vmcnt(4)
Lwk10a:
    s_cbranch_vccz Lwk10b
    s_waitcnt vmcnt(5)
Lwk10b:
    s_waitcnt vmcnt(6)
    buffer_load_dwordx4 v[72:75], v1, s[40:43], s20 offen offset:128 nt
    v_mov_b32 v242, 0
    ds_read_b32 v242, v242 offset:12
    s_waitcnt lgkmcnt(0)
    v_readfirstlane_b32 s12, v242
    s_nop 0
    s_cmp_lg_u32 s12, 2
    s_cselect_b64 vcc, -1, 0
    s_cmp_eq_u32 s12, 1
    s_cbranch_scc0 Lwk11a
    s_waitcnt vmcnt(4)
Lwk11a:
    s_cbranch_vccz Lwk11b
    s_waitcnt vmcnt(5)
Lwk11b:
    s_waitcnt vmcnt(6)
    buffer_load_dwordx4 v[76:79], v1, s[40:43], s20 offen offset:256 nt
    s_cmp_eq_u32 s9, 12
    s_cselect_b32 s11, 12288, s10
    s_add_u32 s21, s20, s11
    s_cmp_eq_u32 s12, 1
    s_cbranch_scc0 Lwk12a
    s_waitcnt vmcnt(4)
Lwk12a:
    s_cbranch_vccz Lwk12b
    s_waitcnt vmcnt(5)
Lwk12b:
    s_waitcnt vmcnt(6)
    buffer_load_dwordx4 v[80:83], v1, s[40:43], s21 offen offset:0 nt
    s_cmp_eq_u32 s12, 1
    s_cbranch_scc0 Lwk13a
    s_waitcnt vmcnt(4)
Lwk13a:
    s_cbranch_vccz Lwk13b
    s_waitcnt vmcnt(5)
Lwk13b:
    s_waitcnt vmcnt(6)
    buffer_load_dwordx4 v[84:87], v1, s[40:43], s21 offen offset:128 nt
    s_cmp_eq_u32 s12, 1
    s_cbranch_scc0 Lwk14a
    s_waitcnt vmcnt(4)
Lwk14a:
    s_cbranch_vccz Lwk14b
    s_waitcnt vmcnt(5)
Lwk14b:
    s_waitcnt vmcnt(6)
    buffer_load_dwordx4 v[88:91], v1, s[40:43], s21 offen offset:256 nt
    s_cmp_eq_u32 s9, 11
    s_cselect_b32 s11, 12288, s10
    s_add_u32 s22, s21, s11
    s_cmp_eq_u32 s12, 1
    s_cbranch_scc0 Lwk15a
    s_waitcnt vmcnt(4)
Lwk15a:
    s_cbranch_vccz Lwk15b
    s_waitcnt vmcnt(5)
Lwk15b:
    s_waitcnt vmcnt(6)
    buffer_load_dwordx4 v[92:95], v1, s[40:43], s22 offen offset:0 nt
    s_cmp_eq_u32 s12, 1
    s_cbranch_scc0 Lwk16a
    s_waitcnt vmcnt(4)
Lwk16a:
    s_cbranch_vccz Lwk16b
    s_waitcnt vmcnt(5)
Lwk16b:
    s_waitcnt vmcnt(6)
    buffer_load_dwordx4 v[96:99], v1, s[40:43], s22 offen offset:128 nt
    s_cmp_eq_u32 s12, 1
    s_cbranch_scc0 Lwk17a
    s_waitcnt vmcnt(4)
Lwk17a:
    s_cbranch_vccz Lwk17b
    s_waitcnt vmcnt(5)
Lwk17b:
    s_waitcnt vmcnt(6)
    buffer_load_dwordx4 v[100:103], v1, s[40:43], s22 offen offset:256 nt
    s_cmp_eq_u32 s9, 10
    s_cselect_b32 s11, 12288, s10
    s_add_u32 s23, s22, s11
    s_cmp_eq_u32 s12, 1
    s_cbranch_scc0 Lwk18a
    s_waitcnt vmcnt(4)
Lwk18a:
    s_cbranch_vccz Lwk18b
    s_waitcnt vmcnt(5)
Lwk18b:
    s_waitcnt vmcnt(6)
    buffer_load_dwordx4 v[104:107], v1, s[40:43], s23 offen offset:0 nt
    s_cmp_eq_u32 s12, 1
    s_cbranch_scc0 Lwk19a
    s_waitcnt vmcnt(4)
Lwk19a:
    s_cbranch_vccz Lwk19b
    s_waitcnt vmcnt(5)
Lwk19b:
    s_waitcnt vmcnt(6)
    buffer_load_dwordx4 v[108:111], v1, s[40:43], s23 offen offset:128 nt
    s_cmp_eq_u32 s12, 1
    s_cbranch_scc0 Lwk20a
    s_waitcnt vmcnt(4)
Lwk20a:
    s_cbranch_vccz Lwk20b
    s_waitcnt vmcnt(5)
Lwk20b:
    s_waitcnt vmcnt(6)
    buffer_load_dwordx4 v[112:115], v1, s[40:43], s23 offen offset:256 nt
    s_cmp_eq_u32 s9, 9
    s_cselect_b32 s11, 12288, s10
    s_add_u32 s26, s23, s11
    v_mov_b32 v31, 0
    ds_read_b32 v27, v31 offset:0
    s_cmp_eq_u32 s12, 1
    s_cbranch_scc0 Lwk21a
    s_waitcnt vmcnt(4)
Lwk21a:
    s_cbranch_vccz Lwk21b
    s_waitcnt vmcnt(5)
Lwk21b:
    s_waitcnt vmcnt(6)
    buffer_load_dwordx4 v[116:119], v1, s[40:43], s26 offen offset:0 nt
    s_cmp_eq_u32 s12, 1
    s_cbranch_scc0 Lwk22a
    s_waitcnt vmcnt(4)
Lwk22a:
    s_cbranch_vccz Lwk22b
    s_waitcnt vmcnt(5)
Lwk22b:
    s_waitcnt vmcnt(6)
    buffer_load_dwordx4 v[120:123], v1, s[40:43], s26 offen offset:128 nt
    s_cmp_eq_u32 s12, 1
    s_cbranch_scc0 Lwk23a
    s_waitcnt vmcnt(4)
Lwk23a:
    s_cbranch_vccz Lwk23b
    s_waitcnt vmcnt(5)
Lwk23b:
    s_waitcnt vmcnt(6)
    buffer_load_dwordx4 v[124:127], v1, s[40:43], s26 offen offset:256 nt
    s_cmp_eq_u32 s3, 0
    s_waitcnt lgkmcnt(0)
    v_readfirstlane_b32 s27, v27
    s_cbranch_scc0 L_x1
    s_mov_b64 exec, 0xff
    buffer_load_dword v27, v29, s[48:51], s13 offen sc1
    s_mov_b64 exec, -1
L_x1:
    s_lshl2_add_u32 s7, s3, s27
    s_and_b32 s7, s7, 15
    s_cmp_lg_u32 s7, 10
    s_cbranch_scc1 L_x2
    s_lshl3_add_u32 s7, s3, 16
    s_mov_b32 exec_hi, 0
    s_add_u32 s6, s13, s7
    buffer_load_ubyte v243, v0, s[48:51], s6 offen sc1
    s_mov_b32 exec_lo, 1
    s_add_u32 s6, s6, s5
    v_mov_b32 v241, 1
    buffer_store_byte v241, off, s[48:51], s6
    s_mov_b64 exec, -1
L_x2:
    s_cmp_eq_u32 s3, 0
    s_barrier
    s_cbranch_scc1 L_qg
    s_lshl2_add_u32 s7, s3, s27
    s_and_b32 s7, s7, 15
    s_cmp_lg_u32 s7, 10
    s_cbranch_scc1 L_qw
    s_waitcnt vmcnt(1)
    v_cmp_ne_u32 s[6:7], 0, v243
    v_mov_b32 v243, 0
    s_bcnt1_i32_b32 s6, s6
    s_cmp_ge_i32 s6, 21
    s_cselect_b32 s7, 2, 0
    s_cmp_lt_i32 s6, 11
    s_cselect_b32 s7, 1, s7
    v_mov_b32 v241, s7
    ds_write_b32 v243, v241 offset:12
L_qw:
    v_mov_b32 v31, 0
    s_mov_b32 s15, 0x4000000
Lpoll1:
    ds_read_b32 v28, v31 offset:4
    s_waitcnt lgkmcnt(0)
    v_cmp_eq_u32 vcc, 0, v28
    s_cbranch_vccz Lpdone1
    s_sleep 2
    s_sub_u32 s15, s15, 1
    s_cbranch_scc0 Lpoll1
Lpdone1:
    v_readfirstlane_b32 s27, v28
    s_lshr_b32 s7, s3, 2
    s_mul_i32 s11, s7, 384
    v_lshl_add_u32 v28, v3, 4, s11
    ds_read_b128 v[8:11], v28 offset:128
    ds_read_b128 v[12:15], v28 offset:256
    ds_read_b128 v[16:19], v28 offset:384
    s_lshl_b32 s7, s7, 5
    s_add_u32 s7, s7, s5
    s_and_b32 s11, s3, 3
    s_lshl2_add_u32 s7, s7, s11
    s_mul_i32 s11, s4, 100352
    s_lshl3_add_u32 s7, s7, s11
    s_add_u32 s12, s7, 98304
    v_mov_b32 v20, 0
    v_mov_b32 v21, 0
    v_mov_b32 v22, 0
    v_mov_b32 v23, 0
    v_mov_b32 v24, 0
    v_mov_b32 v25, 0
    v_mov_b32 v26, 0
    v_mov_b32 v27, 0
    s_waitcnt vmcnt(0) lgkmcnt(0)
    v_dot2c_f32_bf16 v20, v32, v8
    v_dot2c_f32_bf16 v21, v44, v8
    v_dot2c_f32_bf16 v22, v56, v8
    v_dot2c_f32_bf16 v23, v68, v8
    v_dot2c_f32_bf16 v24, v80, v8
    v_dot2c_f32_bf16 v25, v92, v8
    v_dot2c_f32_bf16 v26, v104, v8
    v_dot2c_f32_bf16 v27, v116, v8
    v_dot2c_f32_bf16 v20, v33, v9
    v_dot2c_f32_bf16 v21, v45, v9
    v_dot2c_f32_bf16 v22, v57, v9
    v_dot2c_f32_bf16 v23, v69, v9
    v_dot2c_f32_bf16 v24, v81, v9
    v_dot2c_f32_bf16 v25, v93, v9
    v_dot2c_f32_bf16 v26, v105, v9
    v_dot2c_f32_bf16 v27, v117, v9
    v_dot2c_f32_bf16 v20, v34, v10
    v_dot2c_f32_bf16 v21, v46, v10
    v_dot2c_f32_bf16 v22, v58, v10
    v_dot2c_f32_bf16 v23, v70, v10
    v_dot2c_f32_bf16 v24, v82, v10
    v_dot2c_f32_bf16 v25, v94, v10
    v_dot2c_f32_bf16 v26, v106, v10
    v_dot2c_f32_bf16 v27, v118, v10
    v_dot2c_f32_bf16 v20, v35, v11
    v_dot2c_f32_bf16 v21, v47, v11
    v_dot2c_f32_bf16 v22, v59, v11
    v_dot2c_f32_bf16 v23, v71, v11
    v_dot2c_f32_bf16 v24, v83, v11
    v_dot2c_f32_bf16 v25, v95, v11
    v_dot2c_f32_bf16 v26, v107, v11
    v_dot2c_f32_bf16 v27, v119, v11
    v_dot2c_f32_bf16 v20, v36, v12
    v_dot2c_f32_bf16 v21, v48, v12
    v_dot2c_f32_bf16 v22, v60, v12
    v_dot2c_f32_bf16 v23, v72, v12
    v_dot2c_f32_bf16 v24, v84, v12
    v_dot2c_f32_bf16 v25, v96, v12
    v_dot2c_f32_bf16 v26, v108, v12
    v_dot2c_f32_bf16 v27, v120, v12
    v_dot2c_f32_bf16 v20, v37, v13
    v_dot2c_f32_bf16 v21, v49, v13
    v_dot2c_f32_bf16 v22, v61, v13
    v_dot2c_f32_bf16 v23, v73, v13
    v_dot2c_f32_bf16 v24, v85, v13
    v_dot2c_f32_bf16 v25, v97, v13
    v_dot2c_f32_bf16 v26, v109, v13
    v_dot2c_f32_bf16 v27, v121, v13
    v_dot2c_f32_bf16 v20, v38, v14
    v_dot2c_f32_bf16 v21, v50, v14
    v_dot2c_f32_bf16 v22, v62, v14
    v_dot2c_f32_bf16 v23, v74, v14
    v_dot2c_f32_bf16 v24, v86, v14
    v_dot2c_f32_bf16 v25, v98, v14
    v_dot2c_f32_bf16 v26, v110, v14
    v_dot2c_f32_bf16 v27, v122, v14
    v_dot2c_f32_bf16 v20, v39, v15
    v_dot2c_f32_bf16 v21, v51, v15
    v_dot2c_f32_bf16 v22, v63, v15
    v_dot2c_f32_bf16 v23, v75, v15
    v_dot2c_f32_bf16 v24, v87, v15
    v_dot2c_f32_bf16 v25, v99, v15
    v_dot2c_f32_bf16 v26, v111, v15
    v_dot2c_f32_bf16 v27, v123, v15
    v_dot2c_f32_bf16 v20, v40, v16
    v_dot2c_f32_bf16 v21, v52, v16
    v_dot2c_f32_bf16 v22, v64, v16
    v_dot2c_f32_bf16 v23, v76, v16
    v_dot2c_f32_bf16 v24, v88, v16
    v_dot2c_f32_bf16 v25, v100, v16
    v_dot2c_f32_bf16 v26, v112, v16
    v_dot2c_f32_bf16 v27, v124, v16
    v_dot2c_f32_bf16 v20, v41, v17
    v_dot2c_f32_bf16 v21, v53, v17
    v_dot2c_f32_bf16 v22, v65, v17
    v_dot2c_f32_bf16 v23, v77, v17
    v_dot2c_f32_bf16 v24, v89, v17
    v_dot2c_f32_bf16 v25, v101, v17
    v_dot2c_f32_bf16 v26, v113, v17
    v_dot2c_f32_bf16 v27, v125, v17
    v_dot2c_f32_bf16 v20, v42, v18
    v_dot2c_f32_bf16 v21, v54, v18
    v_dot2c_f32_bf16 v22, v66, v18
    v_dot2c_f32_bf16 v23, v78, v18
    v_dot2c_f32_bf16 v24, v90, v18
    v_dot2c_f32_bf16 v25, v102, v18
    v_dot2c_f32_bf16 v26, v114, v18
    v_dot2c_f32_bf16 v27, v126, v18
    v_dot2c_f32_bf16 v20, v43, v19
    v_dot2c_f32_bf16 v21, v55, v19
    v_dot2c_f32_bf16 v22, v67, v19
    v_dot2c_f32_bf16 v23, v79, v19
    v_dot2c_f32_bf16 v24, v91, v19
    v_dot2c_f32_bf16 v25, v103, v19
    v_dot2c_f32_bf16 v26, v115, v19
    v_dot2c_f32_bf16 v27, v127, v19
    v_add_f32_dpp v20, v20, v20 quad_perm:[1,0,3,2] row_mask:0xf bank_mask:0xf
    v_add_f32_dpp v21, v21, v21 quad_perm:[1,0,3,2] row_mask:0xf bank_mask:0xf
    v_add_f32_dpp v22, v22, v22 quad_perm:[1,0,3,2] row_mask:0xf bank_mask:0xf
    v_add_f32_dpp v23, v23, v23 quad_perm:[1,0,3,2] row_mask:0xf bank_mask:0xf
    v_add_f32_dpp v24, v24, v24 quad_perm:[1,0,3,2] row_mask:0xf bank_mask:0xf
    v_add_f32_dpp v25, v25, v25 quad_perm:[1,0,3,2] row_mask:0xf bank_mask:0xf
    v_add_f32_dpp v26, v26, v26 quad_perm:[1,0,3,2] row_mask:0xf bank_mask:0xf
    v_add_f32_dpp v27, v27, v27 quad_perm:[1,0,3,2] row_mask:0xf bank_mask:0xf
    v_add_f32_dpp v20, v20, v20 quad_perm:[2,3,0,1] row_mask:0xf bank_mask:0xf
    v_add_f32_dpp v21, v21, v21 quad_perm:[2,3,0,1] row_mask:0xf bank_mask:0xf
    v_add_f32_dpp v22, v22, v22 quad_perm:[2,3,0,1] row_mask:0xf bank_mask:0xf
    v_add_f32_dpp v23, v23, v23 quad_perm:[2,3,0,1] row_mask:0xf bank_mask:0xf
    v_add_f32_dpp v24, v24, v24 quad_perm:[2,3,0,1] row_mask:0xf bank_mask:0xf
    v_add_f32_dpp v25, v25, v25 quad_perm:[2,3,0,1] row_mask:0xf bank_mask:0xf
    v_add_f32_dpp v26, v26, v26 quad_perm:[2,3,0,1] row_mask:0xf bank_mask:0xf
    v_add_f32_dpp v27, v27, v27 quad_perm:[2,3,0,1] row_mask:0xf bank_mask:0xf
    v_add_f32_dpp v20, v20, v20 row_half_mirror row_mask:0xf bank_mask:0xf
    v_add_f32_dpp v21, v21, v21 row_half_mirror row_mask:0xf bank_mask:0xf
    v_add_f32_dpp v22, v22, v22 row_half_mirror row_mask:0xf bank_mask:0xf
    v_add_f32_dpp v23, v23, v23 row_half_mirror row_mask:0xf bank_mask:0xf
    v_add_f32_dpp v24, v24, v24 row_half_mirror row_mask:0xf bank_mask:0xf
    v_add_f32_dpp v25, v25, v25 row_half_mirror row_mask:0xf bank_mask:0xf
    v_add_f32_dpp v26, v26, v26 row_half_mirror row_mask:0xf bank_mask:0xf
    v_add_f32_dpp v27, v27, v27 row_half_mirror row_mask:0xf bank_mask:0xf
    v_cvt_pk_bf16_f32 v21, v20, v21
    v_lshlrev_b32 v20, 16, v21
    v_and_b32 v21, 0xffff0000, v21
    v_cvt_pk_bf16_f32 v23, v22, v23
    v_lshlrev_b32 v22, 16, v23
    v_and_b32 v23, 0xffff0000, v23
    v_cvt_pk_bf16_f32 v25, v24, v25
    v_lshlrev_b32 v24, 16, v25
    v_and_b32 v25, 0xffff0000, v25
    v_cvt_pk_bf16_f32 v27, v26, v27
    v_lshlrev_b32 v26, 16, v27
    v_and_b32 v27, 0xffff0000, v27
    v_mul_f32 v20, 0x3d93cd3a, v20
    v_mul_f32 v21, 0x3d93cd3a, v21
    v_mul_f32 v22, 0x3d93cd3a, v22
    v_mul_f32 v23, 0x3d93cd3a, v23
    v_mul_f32 v24, 0x3d93cd3a, v24
    v_mul_f32 v25, 0x3d93cd3a, v25
    v_mul_f32 v26, 0x3d93cd3a, v26
    v_mul_f32 v27, 0x3d93cd3a, v27
    v_cvt_pk_bf16_f32 v21, v20, v21
    v_lshlrev_b32 v20, 16, v21
    v_and_b32 v21, 0xffff0000, v21
    v_cvt_pk_bf16_f32 v23, v22, v23
    v_lshlrev_b32 v22, 16, v23
    v_and_b32 v23, 0xffff0000, v23
    v_cvt_pk_bf16_f32 v25, v24, v25
    v_lshlrev_b32 v24, 16, v25
    v_and_b32 v25, 0xffff0000, v25
    v_cvt_pk_bf16_f32 v27, v26, v27
    v_lshlrev_b32 v26, 16, v27
    v_and_b32 v27, 0xffff0000, v27
    v_max3_f32 v244, v20, v21, v22
    v_max3_f32 v244, v244, v23, v24
    v_max3_f32 v244, v244, v25, v26
    v_max_f32 v244, v244, v27
    s_nop 1
    v_max_f32_dpp v244, v244, v244 row_ror:8 row_mask:0xf bank_mask:0xf
    v_mov_b32 v28, v244
    s_nop 1
    v_permlane16_swap_b32 v244, v28
    v_max_f32 v244, v244, v28
    v_mov_b32 v28, v244
    s_nop 1
    v_permlane32_swap_b32 v244, v28
    v_max_f32 v244, v244, v28
    s_branch L_po1
L_pad1:
    s_branch L_e0
L_po1:
    v_sub_f32 v20, v20, v244
    v_sub_f32 v21, v21, v244
    v_sub_f32 v22, v22, v244
    v_sub_f32 v23, v23, v244
    v_sub_f32 v24, v24, v244
    v_sub_f32 v25, v25, v244
    v_sub_f32 v26, v26, v244
    v_sub_f32 v27, v27, v244
    v_mul_f32 v20, 0x3fb8aa3b, v20
    v_mul_f32 v21, 0x3fb8aa3b, v21
    v_mul_f32 v22, 0x3fb8aa3b, v22
    v_mul_f32 v23, 0x3fb8aa3b, v23
    v_mul_f32 v24, 0x3fb8aa3b, v24
    v_mul_f32 v25, 0x3fb8aa3b, v25
    v_mul_f32 v26, 0x3fb8aa3b, v26
    v_mul_f32 v27, 0x3fb8aa3b, v27
    v_exp_f32 v20, v20
    v_exp_f32 v21, v21
    v_exp_f32 v22, v22
    v_exp_f32 v23, v23
    v_exp_f32 v24, v24
    v_exp_f32 v25, v25
    v_exp_f32 v26, v26
    v_exp_f32 v27, v27
    v_add_f32 v9, v20, v21
    v_add_f32 v9, v9, v22
    v_add_f32 v9, v9, v23
    v_add_f32 v9, v9, v24
    v_add_f32 v9, v9, v25
    v_add_f32 v9, v9, v26
    v_add_f32 v9, v9, v27
    s_nop 1
    v_add_f32_dpp v9, v9, v9 row_ror:8 row_mask:0xf bank_mask:0xf
    v_mov_b32 v28, v9
    s_nop 1
    v_permlane16_swap_b32 v9, v28
    v_add_f32 v9, v9, v28
    v_mov_b32 v28, v9
    s_nop 1
    v_permlane32_swap_b32 v9, v28
    v_add_f32 v9, v9, v28
    s_mul_i32 s7, s3, 1536
    v_lshrrev_b32 v29, 5, v0
    v_mul_u32_u24 v29, 768, v29
    v_add_u32 v29, s7, v29
    v_and_b32 v28, 16, v0
    v_lshl_add_u32 v28, v3, 5, v28
    v_add_u32 v30, v28, v29
    v_mov_b32 v8, v244
    s_cmp_eq_u32 s27, 1
    s_mov_b64 exec, 1
    s_cbranch_scc0 L_mlg
    buffer_store_dwordx2 v[8:9], off, s[48:51], s12
L_mld:
    s_mov_b64 exec, -1
    s_barrier
    buffer_load_dwordx4 v[128:131], v1, s[44:47], s8 offen offset:0 nt
    v_mov_b32 v242, 0
    ds_read_b32 v242, v242 offset:12
    v_cvt_pk_bf16_f32 v35, v20, v20
    v_and_b32 v32, v4, v35
    v_and_b32 v33, v5, v35
    v_and_b32 v34, v6, v35
    v_and_b32 v35, v7, v35
    v_cvt_pk_bf16_f32 v39, v21, v21
    v_and_b32 v36, v4, v39
    v_and_b32 v37, v5, v39
    v_and_b32 v38, v6, v39
    v_and_b32 v39, v7, v39
    buffer_load_dwordx4 v[132:135], v1, s[44:47], s8 offen offset:128 nt
    v_cvt_pk_bf16_f32 v43, v22, v22
    v_and_b32 v40, v4, v43
    v_and_b32 v41, v5, v43
    v_and_b32 v42, v6, v43
    v_and_b32 v43, v7, v43
    v_cvt_pk_bf16_f32 v47, v23, v23
    v_and_b32 v44, v4, v47
    v_and_b32 v45, v5, v47
    v_and_b32 v46, v6, v47
    v_and_b32 v47, v7, v47
    buffer_load_dwordx4 v[136:139], v1, s[44:47], s8 offen offset:256 nt
    v_cvt_pk_bf16_f32 v51, v24, v24
    v_and_b32 v48, v4, v51
    v_and_b32 v49, v5, v51
    v_and_b32 v50, v6, v51
    v_and_b32 v51, v7, v51
    v_cvt_pk_bf16_f32 v55, v25, v25
    v_and_b32 v52, v4, v55
    v_and_b32 v53, v5, v55
    v_and_b32 v54, v6, v55
    v_and_b32 v55, v7, v55
    buffer_load_dwordx4 v[140:143], v1, s[44:47], s18 offen offset:0 nt
    v_cvt_pk_bf16_f32 v59, v26, v26
    v_and_b32 v56, v4, v59
    v_and_b32 v57, v5, v59
    v_and_b32 v58, v6, v59
    v_and_b32 v59, v7, v59
    v_cvt_pk_bf16_f32 v63, v27, v27
    v_and_b32 v60, v4, v63
    v_and_b32 v61, v5, v63
    v_and_b32 v62, v6, v63
    v_and_b32 v63, v7, v63
    buffer_load_dwordx4 v[144:147], v1, s[44:47], s18 offen offset:128 nt
    s_waitcnt lgkmcnt(0)
    v_readfirstlane_b32 s12, v242
    s_nop 0
    s_cmp_lg_u32 s12, 2
    s_cselect_b64 vcc, -1, 0
    s_cmp_eq_u32 s12, 1
    s_cbranch_scc0 Lwv5a
    s_waitcnt vmcnt(4)
Lwv5a:
    s_cbranch_vccz Lwv5b
    s_waitcnt vmcnt(5)
Lwv5b:
    buffer_load_dwordx4 v[148:151], v1, s[44:47], s18 offen offset:256 nt
    s_cmp_eq_u32 s12, 1
    s_cbranch_scc0 Lwv6a
    s_waitcnt vmcnt(4)
Lwv6a:
    s_cbranch_vccz Lwv6b
    s_waitcnt vmcnt(5)
Lwv6b:
    buffer_load_dwordx4 v[152:155], v1, s[44:47], s19 offen offset:0 nt
    s_cmp_eq_u32 s12, 1
    s_cbranch_scc0 Lwv7a
    s_waitcnt vmcnt(4)
Lwv7a:
    s_cbranch_vccz Lwv7b
    s_waitcnt vmcnt(5)
Lwv7b:
    s_waitcnt vmcnt(6)
    buffer_load_dwordx4 v[156:159], v1, s[44:47], s19 offen offset:128 nt
    v_mov_b32 v242, 0
    ds_read_b32 v242, v242 offset:12
    s_waitcnt lgkmcnt(0)
    v_readfirstlane_b32 s12, v242
    s_nop 0
    s_cmp_lg_u32 s12, 2
    s_cselect_b64 vcc, -1, 0
    s_cmp_eq_u32 s12, 1
    s_cbranch_scc0 Lwv8a
    s_waitcnt vmcnt(4)
Lwv8a:
    s_cbranch_vccz Lwv8b
    s_waitcnt vmcnt(5)
Lwv8b:
    s_waitcnt vmcnt(6)
    buffer_load_dwordx4 v[160:163], v1, s[44:47], s19 offen offset:256 nt
    s_cmp_eq_u32 s12, 1
    s_cbranch_scc0 Lwv9a
    s_waitcnt vmcnt(4)
Lwv9a:
    s_cbranch_vccz Lwv9b
    s_waitcnt vmcnt(5)
Lwv9b:
    s_waitcnt vmcnt(6)
    buffer_load_dwordx4 v[164:167], v1, s[44:47], s20 offen offset:0 nt
    s_cmp_eq_u32 s12, 1
    s_cbranch_scc0 Lwv10a
    s_waitcnt vmcnt(4)
Lwv10a:
    s_cbranch_vccz Lwv10b
    s_waitcnt vmcnt(5)
Lwv10b:
    s_waitcnt vmcnt(6)
    buffer_load_dwordx4 v[168:171], v1, s[44:47], s20 offen offset:128 nt
    v_mov_b32 v242, 0
    ds_read_b32 v242, v242 offset:12
    s_waitcnt lgkmcnt(0)
    v_readfirstlane_b32 s12, v242
    s_nop 0
    s_cmp_lg_u32 s12, 2
    s_cselect_b64 vcc, -1, 0
    s_cmp_eq_u32 s12, 1
    s_cbranch_scc0 Lwv11a
    s_waitcnt vmcnt(4)
Lwv11a:
    s_cbranch_vccz Lwv11b
    s_waitcnt vmcnt(5)
Lwv11b:
    s_waitcnt vmcnt(6)
    buffer_load_dwordx4 v[172:175], v1, s[44:47], s20 offen offset:256 nt
    v_mfma_f32_16x16x32_bf16 v[224:227], v[32:35], v[128:131], 0
    v_mfma_f32_16x16x32_bf16 v[228:231], v[32:35], v[132:135], 0
    v_mfma_f32_16x16x32_bf16 v[232:235], v[32:35], v[136:139], 0
    s_cmp_eq_u32 s12, 1
    s_cbranch_scc0 Lwv12a
    s_waitcnt vmcnt(4)
Lwv12a:
    s_cbranch_vccz Lwv12b
    s_waitcnt vmcnt(5)
Lwv12b:
    s_waitcnt vmcnt(6)
    buffer_load_dwordx4 v[176:179], v1, s[44:47], s21 offen offset:0 nt
    s_cmp_eq_u32 s12, 1
    s_cbranch_scc0 Lwv13a
    s_waitcnt vmcnt(4)
Lwv13a:
    s_cbranch_vccz Lwv13b
    s_waitcnt vmcnt(5)
Lwv13b:
    s_waitcnt vmcnt(6)
    buffer_load_dwordx4 v[180:183], v1, s[44:47], s21 offen offset:128 nt
    s_cmp_eq_u32 s12, 1
    s_cbranch_scc0 Lwv14a
    s_waitcnt vmcnt(4)
Lwv14a:
    s_cbranch_vccz Lwv14b
    s_waitcnt vmcnt(5)
Lwv14b:
    s_waitcnt vmcnt(6)
    buffer_load_dwordx4 v[184:187], v1, s[44:47], s21 offen offset:256 nt
    v_mfma_f32_16x16x32_bf16 v[224:227], v[36:39], v[140:143], v[224:227]
    v_mfma_f32_16x16x32_bf16 v[228:231], v[36:39], v[144:147], v[228:231]
    v_mfma_f32_16x16x32_bf16 v[232:235], v[36:39], v[148:151], v[232:235]
    s_cmp_eq_u32 s12, 1
    s_cbranch_scc0 Lwv15a
    s_waitcnt vmcnt(4)
Lwv15a:
    s_cbranch_vccz Lwv15b
    s_waitcnt vmcnt(5)
Lwv15b:
    s_waitcnt vmcnt(6)
    buffer_load_dwordx4 v[188:191], v1, s[44:47], s22 offen offset:0 nt
    s_cmp_eq_u32 s12, 1
    s_cbranch_scc0 Lwv16a
    s_waitcnt vmcnt(4)
Lwv16a:
    s_cbranch_vccz Lwv16b
    s_waitcnt vmcnt(5)
Lwv16b:
    s_waitcnt vmcnt(6)
    buffer_load_dwordx4 v[192:195], v1, s[44:47], s22 offen offset:128 nt
    s_cmp_eq_u32 s12, 1
    s_cbranch_scc0 Lwv17a
    s_waitcnt vmcnt(4)
Lwv17a:
    s_cbranch_vccz Lwv17b
    s_waitcnt vmcnt(5)
Lwv17b:
    s_waitcnt vmcnt(6)
    buffer_load_dwordx4 v[196:199], v1, s[44:47], s22 offen offset:256 nt
    v_mfma_f32_16x16x32_bf16 v[224:227], v[40:43], v[152:155], v[224:227]
    v_mfma_f32_16x16x32_bf16 v[228:231], v[40:43], v[156:159], v[228:231]
    v_mfma_f32_16x16x32_bf16 v[232:235], v[40:43], v[160:163], v[232:235]
    s_cmp_eq_u32 s12, 1
    s_cbranch_scc0 Lwv18a
    s_waitcnt vmcnt(4)
Lwv18a:
    s_cbranch_vccz Lwv18b
    s_waitcnt vmcnt(5)
Lwv18b:
    s_waitcnt vmcnt(6)
    buffer_load_dwordx4 v[200:203], v1, s[44:47], s23 offen offset:0 nt
    s_cmp_eq_u32 s12, 1
    s_cbranch_scc0 Lwv19a
    s_waitcnt vmcnt(4)
Lwv19a:
    s_cbranch_vccz Lwv19b
    s_waitcnt vmcnt(5)
Lwv19b:
    s_waitcnt vmcnt(6)
    buffer_load_dwordx4 v[204:207], v1, s[44:47], s23 offen offset:128 nt
    s_cmp_eq_u32 s12, 1
    s_cbranch_scc0 Lwv20a
    s_waitcnt vmcnt(4)
Lwv20a:
    s_cbranch_vccz Lwv20b
    s_waitcnt vmcnt(5)
Lwv20b:
    s_waitcnt vmcnt(6)
    buffer_load_dwordx4 v[208:211], v1, s[44:47], s23 offen offset:256 nt
    v_mfma_f32_16x16x32_bf16 v[224:227], v[44:47], v[164:167], v[224:227]
    v_mfma_f32_16x16x32_bf16 v[228:231], v[44:47], v[168:171], v[228:231]
    v_mfma_f32_16x16x32_bf16 v[232:235], v[44:47], v[172:175], v[232:235]
    s_cmp_eq_u32 s12, 1
    s_cbranch_scc0 Lwv21a
    s_waitcnt vmcnt(4)
Lwv21a:
    s_cbranch_vccz Lwv21b
    s_waitcnt vmcnt(5)
Lwv21b:
    s_waitcnt vmcnt(6)
    buffer_load_dwordx4 v[212:215], v1, s[44:47], s26 offen offset:0 nt
    s_cmp_eq_u32 s12, 1
    s_cbranch_scc0 Lwv22a
    s_waitcnt vmcnt(4)
Lwv22a:
    s_cbranch_vccz Lwv22b
    s_waitcnt vmcnt(5)
Lwv22b:
    s_waitcnt vmcnt(6)
    buffer_load_dwordx4 v[216:219], v1, s[44:47], s26 offen offset:128 nt
    s_cmp_eq_u32 s12, 1
    s_cbranch_scc0 Lwv23a
    s_waitcnt vmcnt(4)
Lwv23a:
    s_cbranch_vccz Lwv23b
    s_waitcnt vmcnt(5)
Lwv23b:
    s_waitcnt vmcnt(6)
    buffer_load_dwordx4 v[220:223], v1, s[44:47], s26 offen offset:256 nt
    s_lshl2_add_u32 s7, s3, s27
    s_cmp_lg_u32 s7, 9
    s_cbranch_scc1 L_x4
    s_mov_b32 exec_hi, 0
    s_add_u32 s6, s13, 96
    buffer_load_ubyte v243, v0, s[48:51], s6 offen sc1
    s_mov_b32 exec_lo, 1
    s_add_u32 s6, s6, s5
    v_mov_b32 v241, 1
    buffer_store_byte v241, off, s[48:51], s6
    s_mov_b64 exec, -1
L_x4:
    s_cmp_lg_u32 s7, 9
    s_barrier
    s_cbranch_scc1 L_x3
    s_waitcnt vmcnt(1)
    v_cmp_ne_u32 s[6:7], 0, v243
    v_mov_b32 v243, 0
    s_bcnt1_i32_b32 s6, s6
    s_cmp_ge_i32 s6, 21
    s_cselect_b32 s7, 2, 0
    s_cmp_lt_i32 s6, 11
    s_cselect_b32 s7, 1, s7
    v_mov_b32 v241, s7
    ds_write_b32 v243, v241 offset:12
L_x3:
    v_mfma_f32_16x16x32_bf16 v[224:227], v[48:51], v[176:179], v[224:227]
    v_mfma_f32_16x16x32_bf16 v[228:231], v[48:51], v[180:183], v[228:231]
    v_mfma_f32_16x16x32_bf16 v[232:235], v[48:51], v[184:187], v[232:235]
    v_mfma_f32_16x16x32_bf16 v[224:227], v[52:55], v[188:191], v[224:227]
    v_mfma_f32_16x16x32_bf16 v[228:231], v[52:55], v[192:195], v[228:231]
    s_waitcnt vmcnt(6)
    v_mfma_f32_16x16x32_bf16 v[232:235], v[52:55], v[196:199], v[232:235]
    s_waitcnt vmcnt(5)
    v_mfma_f32_16x16x32_bf16 v[224:227], v[56:59], v[200:203], v[224:227]
    s_waitcnt vmcnt(4)
    v_mfma_f32_16x16x32_bf16 v[228:231], v[56:59], v[204:207], v[228:231]
    s_waitcnt vmcnt(3)
    v_mfma_f32_16x16x32_bf16 v[232:235], v[56:59], v[208:211], v[232:235]
    s_waitcnt vmcnt(2)
    v_mfma_f32_16x16x32_bf16 v[224:227], v[60:63], v[212:215], v[224:227]
    s_waitcnt vmcnt(1)
    v_mfma_f32_16x16x32_bf16 v[228:231], v[60:63], v[216:219], v[228:231]
    s_waitcnt vmcnt(0)
    v_mfma_f32_16x16x32_bf16 v[232:235], v[60:63], v[220:223], v[232:235]
    s_mov_b32 exec_lo, 0x00ff00ff
    s_mov_b32 exec_hi, 0xff00ff00
    s_cmp_lt_u32 s3, 4
    s_nop 0
    ds_write_b128 v30, v[224:227] offset:1024
    s_nop 0
    ds_write_b128 v30, v[228:231] offset:1280
    s_nop 0
    ds_write_b128 v30, v[232:235] offset:1536
    s_cbranch_scc1 L_early
    s_waitcnt lgkmcnt(0)
    s_barrier
    s_endpgm
L_mlg:
    buffer_store_dwordx2 v[8:9], off, s[48:51], s12 sc1
    s_branch L_mld
.p2align 12
L_pad2:
    s_branch L_e0
L_qg:
    s_mov_b64 s[64:65], s[36:37]
    s_mov_b32 s66, 256
    s_mov_b32 s67, 0x20000
    v_mov_b32 v31, 0
    ds_read_b32 v28, v31 offset:0
    s_lshl_b32 s12, s4, 5
    s_mul_i32 s14, s4, 100352
    v_lshlrev_b32 v31, 4, v0
    s_mov_b32 s15, 200000
    s_waitcnt lgkmcnt(0)
    v_cmp_eq_u32 vcc, 1, v28
    s_cbranch_vccnz L_qgg
    s_mov_b64 exec, 0xff
    s_cmp_eq_u32 s27, 2
    s_cbranch_scc1 L_qgi
L_qgh:
    buffer_load_dword v27, v29, s[48:51], s13 offen sc1
L_qgi:
    s_waitcnt vmcnt(0)
    v_cmp_ne_u32 vcc, 0x01010101, v27
    s_cbranch_vccz L_qgl
    s_sub_u32 s15, s15, 1
    s_cbranch_scc1 L_qgl
    s_cmp_gt_u32 s15, 199998
    s_cbranch_scc1 L_qgh
    buffer_load_dword v28, off, s[64:67], s12 offset:8 sc1
    s_waitcnt vmcnt(0)
    v_cmp_eq_u32 vcc, 0, v28
    s_cbranch_vccnz L_qgh
L_qgg:
    s_mov_b64 exec, -1
    v_mov_b32 v128, -1
    v_mov_b32 v129, -1
    v_mov_b32 v130, -1
    v_mov_b32 v131, -1
    ds_read_b128 v[192:195], v247 offset:28416
    ds_read_b128 v[196:199], v247 offset:28928
    ds_read_b128 v[200:203], v247 offset:29440
    s_mul_i32 s71, s5, 3072
    s_add_u32 s71, s71, s14
    buffer_store_dwordx4 v[128:131], v31, s[48:51], s71 offen offset:2048 sc1
    s_mov_b32 exec_hi, 0
    buffer_store_dwordx4 v[128:131], v31, s[48:51], s71 offen offset:1536 sc1
    s_cmp_ge_u32 s5, 16
    s_cbranch_scc1 L_qgm
    s_lshl_b32 s11, s5, 7
    s_add_u32 s11, s11, s14
    s_add_u32 s11, s11, 98304
    s_mov_b64 exec, 0xff
    buffer_store_dwordx4 v[128:131], v31, s[48:51], s11 offen sc1
L_qgm:
    s_mov_b32 exec_lo, 0x00ff00ff
    s_mov_b32 exec_hi, 0x00ff00ff
    s_waitcnt lgkmcnt(0)
    buffer_store_dwordx4 v[192:195], v247, s[48:51], s71 offen offset:0 sc1
    buffer_store_dwordx4 v[196:199], v247, s[48:51], s71 offen offset:512 sc1
    buffer_store_dwordx4 v[200:203], v247, s[48:51], s71 offen offset:1024 sc1
    s_mov_b32 s11, 1
    s_add_u32 s7, s12, 8
    s_waitcnt vmcnt(0)
    s_atomic_add s11, s[36:37], s7 glc
    s_waitcnt lgkmcnt(0)
    s_mov_b64 exec, 1
    s_mov_b32 s15, 200000
Lpoll6:
    buffer_load_dword v28, off, s[64:67], s12 offset:8 sc1
    s_waitcnt vmcnt(0)
    v_cmp_gt_u32 vcc, 32, v28
    s_cbranch_vccz Lpdone6
    s_sleep 4
    s_sub_u32 s15, s15, 1
    s_cbranch_scc0 Lpoll6
Lpdone6:
    s_mov_b32 s27, 2
    s_branch L_qgd
L_pad3:
    s_branch L_e0
L_qgl:
    s_mov_b32 s27, 1
L_qgd:
    s_mov_b32 exec_lo, -1
    s_mov_b32 exec_hi, 0xffff
    s_lshr_b32 s12, s5, 4
    s_mul_i32 s12, s12, 24576
    s_add_u32 s11, s14, s12
    v_lshrrev_b32 v28, 4, v0
    v_lshl_add_u32 v31, v28, 8, v31
    v_and_b32 v29, 8, v0
    v_add_u32 v29, v29, v247
    s_mov_b32 s15, 200000
Lpoll7:
    s_mov_b32 s12, s11
    buffer_load_dwordx4 v[128:131], v31, s[48:51], s12 offen offset:0 sc1
    buffer_load_dwordx4 v[132:135], v31, s[48:51], s12 offen offset:3072 sc1
    s_addk_i32 s12, 6144
    buffer_load_dwordx4 v[136:139], v31, s[48:51], s12 offen offset:0 sc1
    buffer_load_dwordx4 v[140:143], v31, s[48:51], s12 offen offset:3072 sc1
    s_addk_i32 s12, 6144
    buffer_load_dwordx4 v[144:147], v31, s[48:51], s12 offen offset:0 sc1
    buffer_load_dwordx4 v[148:151], v31, s[48:51], s12 offen offset:3072 sc1
    s_addk_i32 s12, 6144
    buffer_load_dwordx4 v[152:155], v31, s[48:51], s12 offen offset:0 sc1
    buffer_load_dwordx4 v[156:159], v31, s[48:51], s12 offen offset:3072 sc1
    s_addk_i32 s12, 30720
    buffer_load_dwordx4 v[160:163], v31, s[48:51], s12 offen offset:0 sc1
    buffer_load_dwordx4 v[164:167], v31, s[48:51], s12 offen offset:3072 sc1
    s_addk_i32 s12, 6144
    buffer_load_dwordx4 v[168:171], v31, s[48:51], s12 offen offset:0 sc1
    buffer_load_dwordx4 v[172:175], v31, s[48:51], s12 offen offset:3072 sc1
    s_addk_i32 s12, 6144
    buffer_load_dwordx4 v[176:179], v31, s[48:51], s12 offen offset:0 sc1
    buffer_load_dwordx4 v[180:183], v31, s[48:51], s12 offen offset:3072 sc1
    s_addk_i32 s12, 6144
    buffer_load_dwordx4 v[184:187], v31, s[48:51], s12 offen offset:0 sc1
    buffer_load_dwordx4 v[188:191], v31, s[48:51], s12 offen offset:3072 sc1
    s_waitcnt vmcnt(0)
    v_max3_u32 v28, v128, v129, v130
    v_max3_u32 v28, v28, v131, v132
    v_max3_u32 v28, v28, v133, v134
    v_max3_u32 v28, v28, v135, v136
    v_max3_u32 v28, v28, v137, v138
    v_max3_u32 v28, v28, v139, v140
    v_max3_u32 v28, v28, v141, v142
    v_max3_u32 v28, v28, v143, v144
    v_max3_u32 v28, v28, v145, v146
    v_max3_u32 v28, v28, v147, v148
    v_max3_u32 v28, v28, v149, v150
    v_max3_u32 v28, v28, v151, v152
    v_max3_u32 v28, v28, v153, v154
    v_max3_u32 v28, v28, v155, v156
    v_max3_u32 v28, v28, v157, v158
    v_max3_u32 v28, v28, v159, v160
    v_max3_u32 v28, v28, v161, v162
    v_max3_u32 v28, v28, v163, v164
    v_max3_u32 v28, v28, v165, v166
    v_max3_u32 v28, v28, v167, v168
    v_max3_u32 v28, v28, v169, v170
    v_max3_u32 v28, v28, v171, v172
    v_max3_u32 v28, v28, v173, v174
    v_max3_u32 v28, v28, v175, v176
    v_max3_u32 v28, v28, v177, v178
    v_max3_u32 v28, v28, v179, v180
    v_max3_u32 v28, v28, v181, v182
    v_max3_u32 v28, v28, v183, v184
    v_max3_u32 v28, v28, v185, v186
    v_max3_u32 v28, v28, v187, v188
    v_max3_u32 v28, v28, v189, v190
    v_max_u32 v28, v28, v191
    v_cmp_eq_u32 vcc, -1, v28
    s_cbranch_vccz Lpdone7
    s_sub_u32 s15, s15, 1
    s_cbranch_scc0 Lpoll7
Lpdone7:
    v_pk_add_f32 v[128:129], v[128:129], v[144:145]
    v_pk_add_f32 v[130:131], v[130:131], v[146:147]
    v_pk_add_f32 v[132:133], v[132:133], v[148:149]
    v_pk_add_f32 v[134:135], v[134:135], v[150:151]
    v_pk_add_f32 v[136:137], v[136:137], v[152:153]
    v_pk_add_f32 v[138:139], v[138:139], v[154:155]
    v_pk_add_f32 v[140:141], v[140:141], v[156:157]
    v_pk_add_f32 v[142:143], v[142:143], v[158:159]
    v_pk_add_f32 v[128:129], v[128:129], v[136:137]
    v_pk_add_f32 v[130:131], v[130:131], v[138:139]
    v_pk_add_f32 v[132:133], v[132:133], v[140:141]
    v_pk_add_f32 v[134:135], v[134:135], v[142:143]
    v_pk_add_f32 v[128:129], v[128:129], v[132:133]
    v_pk_add_f32 v[130:131], v[130:131], v[134:135]
    v_cvt_pk_bf16_f32 v128, v128, v129
    v_cvt_pk_bf16_f32 v129, v130, v131
    ds_write_b64 v29, v[128:129] offset:128
    v_pk_add_f32 v[160:161], v[160:161], v[176:177]
    v_pk_add_f32 v[162:163], v[162:163], v[178:179]
    v_pk_add_f32 v[164:165], v[164:165], v[180:181]
    v_pk_add_f32 v[166:167], v[166:167], v[182:183]
    v_pk_add_f32 v[168:169], v[168:169], v[184:185]
    v_pk_add_f32 v[170:171], v[170:171], v[186:187]
    v_pk_add_f32 v[172:173], v[172:173], v[188:189]
    v_pk_add_f32 v[174:175], v[174:175], v[190:191]
    v_pk_add_f32 v[160:161], v[160:161], v[168:169]
    v_pk_add_f32 v[162:163], v[162:163], v[170:171]
    v_pk_add_f32 v[164:165], v[164:165], v[172:173]
    v_pk_add_f32 v[166:167], v[166:167], v[174:175]
    v_pk_add_f32 v[160:161], v[160:161], v[164:165]
    v_pk_add_f32 v[162:163], v[162:163], v[166:167]
    v_cvt_pk_bf16_f32 v160, v160, v161
    v_cvt_pk_bf16_f32 v161, v162, v163
    ds_write_b64 v29, v[160:161] offset:512
    v_mov_b32 v26, 0
    v_mov_b32 v27, s27
    s_waitcnt lgkmcnt(0)
    ds_write_b32 v26, v27 offset:4
    s_mov_b64 exec, -1
    s_branch L_qw
.p2align 12
L_pad4:
    s_branch L_lq2
L_early:
    s_mov_b64 exec, 1
    v_mov_b32 v28, 0
    v_mov_b32 v29, 1
    s_waitcnt lgkmcnt(0)
    ds_add_u32 v28, v29 offset:8
    s_mov_b64 exec, -1
    s_mov_b32 s14, s27
    s_mov_b64 s[56:57], s[24:25]
    s_mov_b32 s58, 7864320
    s_mov_b32 s59, 0x20000
    s_mov_b64 s[52:53], s[16:17]
    s_mov_b32 s54, 1280
    s_mov_b32 s55, 0x20000
    s_mov_b64 s[68:69], s[34:35]
    s_mov_b32 s70, 1280
    s_mov_b32 s71, 0x20000
    v_lshlrev_b32 v31, 4, v0
    s_mul_i32 s12, s4, 100352
    s_mul_i32 s13, s5, 52
    s_lshr_b32 s13, s13, 8
    s_mul_i32 s7, s13, 5
    s_sub_u32 s7, s5, s7
    s_mul_i32 s30, s7, 1152
    s_add_u32 s30, s30, 837632
    s_add_u32 s31, s30, 5760
    s_lshl2_add_u32 s6, s13, s3
    s_lshl_b32 s7, s7, 8
    v_lshlrev_b32 v250, 4, v3
    v_and_b32 v28, 8, v0
    v_lshrrev_b32 v29, 4, v0
    v_lshl_add_u32 v28, v28, 1, v29
    v_mul_u32_u24 v248, 1280, v28
    v_add_u32 v248, v248, v250
    v_mul_u32_u24 v249, 3072, v2
    v_add_u32 v249, v249, v250
    s_mul_i32 s10, s6, 43
    s_lshr_b32 s10, s10, 8
    s_and_b32 s11, s10, 1
    s_mul_i32 s11, s11, 48384
    s_lshr_b32 s10, s10, 1
    s_mulk_i32 s10, 768
    s_sub_u32 s11, s11, s10
    s_lshl_b32 s10, s6, 7
    s_add_u32 s11, s11, s10
    s_add_u32 s11, s11, s12
    s_mul_i32 s8, s4, 12
    s_add_u32 s8, s8, s6
    s_cmp_ge_u32 s6, 12
    s_cselect_b32 s10, 84, 0
    s_add_u32 s8, s8, s10
    s_mul_i32 s8, s8, 40960
    s_add_u32 s8, s8, s7
    s_mul_i32 s6, s3, 1536
    v_lshrrev_b32 v28, 5, v0
    v_mul_u32_u24 v28, 768, v28
    v_add_u32 v28, s6, v28
    v_mov_b32 v29, 0x3e000000
    ds_write_b32 v28, v29 offset:13824
    v_and_b32 v29, 0xff, v247
    v_add_u32 v246, v28, v29
    s_mul_i32 s6, s3, 3
    v_lshrrev_b32 v28, 4, v0
    v_add_u32 v28, s6, v28
    v_and_b32 v29, 15, v0
    v_mad_u32_u24 v252, v28, 15, v29
    v_lshlrev_b32 v253, 2, v29
    v_min_u32 v28, 8, v28
    v_lshl_add_u32 v253, v28, 7, v253
    v_cmp_gt_u32 vcc, 0x80, v252
    s_nop 0
    s_and_b32 s26, vcc_lo, 0x7fff7fff
    s_and_b32 s27, vcc_hi, 0x7fff
    s_or_b32 s28, s26, 0x80008000
    s_or_b32 s29, s27, 0x8000
    v_cmp_eq_u32 vcc, 15, v29
    v_lshrrev_b32 v28, 6, v252
    v_bfe_u32 v29, v252, 2, 3
    v_lshl_add_u32 v28, v28, 3, v29
    v_bfe_u32 v29, v252, 5, 1
    v_lshl_add_u32 v28, v28, 1, v29
    v_and_b32 v29, 3, v252
    v_lshl_add_u32 v28, v28, 2, v29
    v_lshl_add_u32 v254, v28, 1, s7
    v_mov_b32 v28, 0x80
    v_cndmask_b32 v252, v252, v28, vcc
    v_lshlrev_b32 v252, 2, v252
    buffer_load_ushort v255, v254, s[52:55], 0 offen
    s_cmp_ge_u32 s3, 2
    s_cbranch_scc1 L_e2
    s_xor_b32 s6, s3, 1
    s_lshr_b32 s10, s5, 4
    s_lshl1_add_u32 s10, s6, s10
    s_lshl_b32 s10, s10, 9
    s_add_u32 s10, s10, s12
    s_add_u32 s10, s10, 98304
    s_lshl2_add_u32 s6, s5, s6
    s_mulk_i32 s6, 768
    s_add_u32 s6, s6, s12
    v_lshlrev_b32 v30, 3, v0
    s_mov_b32 s15, 200000
Lpoll2:
    buffer_load_dwordx2 v[8:9], v30, s[48:51], s10 offen sc1
    s_waitcnt vmcnt(0)
    v_max_u32 v28, v8, v9
    v_cmp_eq_u32 vcc, -1, v28
    s_cbranch_vccz Lpdone2
    s_sleep 2
    s_sub_u32 s15, s15, 1
    s_cbranch_scc0 Lpoll2
Lpdone2:
    v_mov_b32 v10, v8
    s_nop 1
    v_max_f32_dpp v10, v10, v10 quad_perm:[1,0,3,2] row_mask:0xf bank_mask:0xf
    s_nop 1
    v_max_f32_dpp v10, v10, v10 quad_perm:[2,3,0,1] row_mask:0xf bank_mask:0xf
    s_nop 1
    v_max_f32_dpp v10, v10, v10 row_half_mirror row_mask:0xf bank_mask:0xf
    s_nop 1
    v_max_f32_dpp v10, v10, v10 row_ror:8 row_mask:0xf bank_mask:0xf
    v_mov_b32 v28, v10
    s_nop 1
    v_permlane16_swap_b32 v10, v28
    v_max_f32 v10, v10, v28
    v_mov_b32 v28, v10
    s_nop 1
    v_permlane32_swap_b32 v10, v28
    v_max_f32 v10, v10, v28
    v_sub_f32 v8, v8, v10
    v_mul_f32 v8, 0x3fb8aa3b, v8
    v_exp_f32 v8, v8
    s_nop 0
    v_mul_f32 v9, v9, v8
    s_nop 1
    v_add_f32_dpp v9, v9, v9 quad_perm:[1,0,3,2] row_mask:0xf bank_mask:0xf
    s_nop 1
    v_add_f32_dpp v9, v9, v9 quad_perm:[2,3,0,1] row_mask:0xf bank_mask:0xf
    s_nop 1
    v_add_f32_dpp v9, v9, v9 row_half_mirror row_mask:0xf bank_mask:0xf
    s_nop 1
    v_add_f32_dpp v9, v9, v9 row_ror:8 row_mask:0xf bank_mask:0xf
    v_mov_b32 v28, v9
    s_nop 1
    v_permlane16_swap_b32 v9, v28
    v_add_f32 v9, v9, v28
    v_mov_b32 v28, v9
    s_nop 1
    v_permlane32_swap_b32 v9, v28
    v_add_f32 v9, v9, v28
    v_rcp_f32 v9, v9
    s_lshl_b32 s10, s9, 2
    v_mul_f32 v8, v8, v9
    s_nop 0
    v_readlane_b32 s60, v8, s10
    s_add_u32 s10, s10, 1
    v_readlane_b32 s62, v8, s10
    s_add_u32 s10, s10, 1
    v_readlane_b32 s64, v8, s10
    s_add_u32 s10, s10, 1
    v_readlane_b32 s66, v8, s10
    s_cmp_eq_u32 s3, 0
    s_cbranch_scc1 L_e2
    v_mov_b32 v29, 0
    s_mov_b32 s15, 0x4000000
Lpoll3:
    ds_read_b32 v28, v29 offset:8
    s_waitcnt lgkmcnt(0)
    v_cmp_gt_u32 vcc, 4, v28
    s_cbranch_vccz Lpdone3
    s_sleep 2
    s_sub_u32 s15, s15, 1
    s_cbranch_scc0 Lpoll3
Lpdone3:
    s_mov_b32 exec_hi, 0xffff
    ds_read_b128 v[160:163], v31 offset:1024
    ds_read_b128 v[164:167], v31 offset:1792
    ds_read_b128 v[168:171], v31 offset:2560
    ds_read_b128 v[172:175], v31 offset:3328
    ds_read_b128 v[176:179], v31 offset:4096
    ds_read_b128 v[180:183], v31 offset:4864
    ds_read_b128 v[184:187], v31 offset:5632
    ds_read_b128 v[188:191], v31 offset:6400
    s_waitcnt lgkmcnt(6)
    v_pk_add_f32 v[160:161], v[160:161], v[164:165]
    v_pk_add_f32 v[162:163], v[162:163], v[166:167]
    v_pk_mul_f32 v[156:157], v[160:161], s[60:61] op_sel_hi:[1,0]
    v_pk_mul_f32 v[158:159], v[162:163], s[60:61] op_sel_hi:[1,0]
    s_waitcnt lgkmcnt(4)
    v_pk_add_f32 v[168:169], v[168:169], v[172:173]
    v_pk_add_f32 v[170:171], v[170:171], v[174:175]
    v_pk_fma_f32 v[156:157], v[168:169], s[62:63], v[156:157] op_sel_hi:[1,0,1]
    v_pk_fma_f32 v[158:159], v[170:171], s[62:63], v[158:159] op_sel_hi:[1,0,1]
    s_waitcnt lgkmcnt(2)
    v_pk_add_f32 v[176:177], v[176:177], v[180:181]
    v_pk_add_f32 v[178:179], v[178:179], v[182:183]
    v_pk_fma_f32 v[156:157], v[176:177], s[64:65], v[156:157] op_sel_hi:[1,0,1]
    v_pk_fma_f32 v[158:159], v[178:179], s[64:65], v[158:159] op_sel_hi:[1,0,1]
    s_waitcnt lgkmcnt(0)
    v_pk_add_f32 v[184:185], v[184:185], v[188:189]
    v_pk_add_f32 v[186:187], v[186:187], v[190:191]
    v_pk_fma_f32 v[156:157], v[184:185], s[66:67], v[156:157] op_sel_hi:[1,0,1]
    v_pk_fma_f32 v[158:159], v[186:187], s[66:67], v[158:159] op_sel_hi:[1,0,1]
    s_cmp_eq_u32 s14, 1
    s_cbranch_scc0 L_pub1g
    buffer_store_dwordx4 v[156:159], v31, s[48:51], s6 offen offset:1536
L_pub1d:
    s_mov_b64 exec, -1
L_e2:
    s_cmp_ge_u32 s5, 30
    s_cbranch_scc1 L_notile
    s_cmp_eq_u32 s3, 3
    s_cbranch_scc1 L_mlp2
    s_waitcnt lgkmcnt(0)
    s_barrier
    ds_read_b32 v26, v252 offset:19456
    s_mov_b64 exec, s[28:29]
    s_waitcnt lgkmcnt(0)
    buffer_atomic_add_f32 v26, v253, s[48:51], s30 offen
    s_mov_b64 exec, -1
L_ea:
    s_add_u32 s10, s11, 24576
    s_cmp_ge_u32 s5, 15
    s_cbranch_scc1 L_eb
    buffer_load_dwordx4 v[192:195], v249, s[48:51], s11 offen offset:1536 sc1
    buffer_load_dwordx4 v[196:199], v249, s[48:51], s10 offen offset:1536 sc1
L_eb:
    buffer_load_dwordx4 v[32:35], v248, s[56:59], s8 offen offset:0 nt
    buffer_load_dwordx4 v[36:39], v248, s[56:59], s8 offen offset:128 nt
    s_addk_i32 s8, 5120
    buffer_load_dwordx4 v[40:43], v248, s[56:59], s8 offen offset:0 nt
    s_cmp_lt_u32 s5, 15
    s_cbranch_scc1 L_ec
    buffer_load_dwordx4 v[44:47], v248, s[56:59], s8 offen offset:128 nt
    s_addk_i32 s8, 5120
    buffer_load_dwordx4 v[48:51], v248, s[56:59], s8 offen offset:0 nt
    buffer_load_dwordx4 v[52:55], v248, s[56:59], s8 offen offset:128 nt
    s_addk_i32 s8, 5120
    buffer_load_dwordx4 v[56:59], v248, s[56:59], s8 offen offset:0 nt
    buffer_load_dwordx4 v[60:63], v248, s[56:59], s8 offen offset:128 nt
L_ec:
    s_waitcnt lgkmcnt(0)
    s_cmp_eq_u32 s3, 0
    s_cbranch_scc1 L_pub
    s_barrier
    s_branch L_og
L_pad5:
    s_branch L_lq2
L_pub:
    s_mov_b32 exec_hi, 0xffff
    s_cmp_eq_u32 s14, 1
    s_barrier
    ds_read_b128 v[160:163], v31 offset:7168
    ds_read_b128 v[164:167], v31 offset:7936
    ds_read_b128 v[168:171], v31 offset:8704
    ds_read_b128 v[172:175], v31 offset:9472
    ds_read_b128 v[176:179], v31 offset:10240
    ds_read_b128 v[180:183], v31 offset:11008
    ds_read_b128 v[184:187], v31 offset:11776
    ds_read_b128 v[188:191], v31 offset:12544
    s_waitcnt lgkmcnt(6)
    v_pk_add_f32 v[160:161], v[160:161], v[164:165]
    v_pk_add_f32 v[162:163], v[162:163], v[166:167]
    v_pk_mul_f32 v[156:157], v[160:161], s[60:61] op_sel_hi:[1,0]
    v_pk_mul_f32 v[158:159], v[162:163], s[60:61] op_sel_hi:[1,0]
    s_waitcnt lgkmcnt(4)
    v_pk_add_f32 v[168:169], v[168:169], v[172:173]
    v_pk_add_f32 v[170:171], v[170:171], v[174:175]
    v_pk_fma_f32 v[156:157], v[168:169], s[62:63], v[156:157] op_sel_hi:[1,0,1]
    v_pk_fma_f32 v[158:159], v[170:171], s[62:63], v[158:159] op_sel_hi:[1,0,1]
    s_waitcnt lgkmcnt(2)
    v_pk_add_f32 v[176:177], v[176:177], v[180:181]
    v_pk_add_f32 v[178:179], v[178:179], v[182:183]
    v_pk_fma_f32 v[156:157], v[176:177], s[64:65], v[156:157] op_sel_hi:[1,0,1]
    v_pk_fma_f32 v[158:159], v[178:179], s[64:65], v[158:159] op_sel_hi:[1,0,1]
    s_waitcnt lgkmcnt(0)
    v_pk_add_f32 v[184:185], v[184:185], v[188:189]
    v_pk_add_f32 v[186:187], v[186:187], v[190:191]
    v_pk_fma_f32 v[156:157], v[184:185], s[66:67], v[156:157] op_sel_hi:[1,0,1]
    v_pk_fma_f32 v[158:159], v[186:187], s[66:67], v[158:159] op_sel_hi:[1,0,1]
    s_cbranch_scc0 L_pubg
    buffer_store_dwordx4 v[156:159], v31, s[48:51], s6 offen offset:1536
L_pubd:
    s_mov_b64 exec, -1
    s_cmp_ge_u32 s5, 30
    s_cbranch_scc1 L_done
L_og:
    s_mov_b32 s15, 200000
    s_cmp_lt_u32 s5, 15
    s_barrier
    s_cbranch_scc1 L_at
L_bt:
    buffer_load_dwordx4 v[192:195], v249, s[48:51], s11 offen offset:1536 sc1
    buffer_load_dwordx4 v[196:199], v249, s[48:51], s10 offen offset:1536 sc1
L_poll:
    s_waitcnt vmcnt(0)
    buffer_load_dwordx4 v[200:203], v249, s[48:51], s11 offen offset:1536 sc1
    buffer_load_dwordx4 v[204:207], v249, s[48:51], s10 offen offset:1536 sc1
    v_pk_add_f32 v[16:17], v[192:193], v[196:197]
    v_pk_add_f32 v[18:19], v[194:195], v[198:199]
    v_max3_u32 v28, v192, v193, v194
    v_max3_u32 v29, v195, v196, v197
    v_permlane32_swap_b32 v16, v18
    v_permlane32_swap_b32 v17, v19
    v_pk_add_f32 v[16:17], v[16:17], v[18:19]
    v_max3_u32 v28, v28, v198, v199
    v_max_u32 v28, v28, v29
    v_permlane16_swap_b32 v16, v17
    v_add_f32 v16, v16, v17
    v_cmp_eq_u32 vcc, -1, v28
    s_cbranch_vccz L_got
    s_waitcnt vmcnt(0)
    buffer_load_dwordx4 v[192:195], v249, s[48:51], s11 offen offset:1536 sc1
    buffer_load_dwordx4 v[196:199], v249, s[48:51], s10 offen offset:1536 sc1
    v_pk_add_f32 v[16:17], v[200:201], v[204:205]
    v_pk_add_f32 v[18:19], v[202:203], v[206:207]
    v_max3_u32 v28, v200, v201, v202
    v_max3_u32 v29, v203, v204, v205
    v_permlane32_swap_b32 v16, v18
    v_permlane32_swap_b32 v17, v19
    v_pk_add_f32 v[16:17], v[16:17], v[18:19]
    v_max3_u32 v28, v28, v206, v207
    v_max_u32 v28, v28, v29
    v_permlane16_swap_b32 v16, v17
    v_add_f32 v16, v16, v17
    v_cmp_eq_u32 vcc, -1, v28
    s_cbranch_vccnz L_retry
L_got:
    v_add_f32_dpp v16, v16, v16 row_ror:8 row_mask:0xf bank_mask:0xf
    v_cvt_pk_bf16_f32 v16, v16, v16
    buffer_load_dword v15, v253, s[48:51], s30 offen sc1
    s_nop 0
    v_mov_b32_dpp v16, v16 row_shr:4 row_mask:0xf bank_mask:0x6
    s_nop 1
    v_and_b32_dpp v128, v16, v4 quad_perm:[0,0,0,0] row_mask:0xf bank_mask:0xf
    v_and_b32_dpp v129, v16, v5 quad_perm:[0,0,0,0] row_mask:0xf bank_mask:0xf
    v_and_b32_dpp v130, v16, v6 quad_perm:[0,0,0,0] row_mask:0xf bank_mask:0xf
    v_and_b32_dpp v131, v16, v7 quad_perm:[0,0,0,0] row_mask:0xf bank_mask:0xf
    v_and_b32_dpp v132, v16, v4 quad_perm:[1,1,1,1] row_mask:0xf bank_mask:0xf
    v_and_b32_dpp v133, v16, v5 quad_perm:[1,1,1,1] row_mask:0xf bank_mask:0xf
    v_mfma_f32_16x16x32_bf16 v[224:227], v[128:131], v[32:35], 0
    v_and_b32_dpp v134, v16, v6 quad_perm:[1,1,1,1] row_mask:0xf bank_mask:0xf
    v_and_b32_dpp v135, v16, v7 quad_perm:[1,1,1,1] row_mask:0xf bank_mask:0xf
    v_mfma_f32_16x16x32_bf16 v[228:231], v[128:131], v[36:39], 0
    v_and_b32_dpp v136, v16, v4 quad_perm:[2,2,2,2] row_mask:0xf bank_mask:0xf
    v_and_b32_dpp v137, v16, v5 quad_perm:[2,2,2,2] row_mask:0xf bank_mask:0xf
    v_mfma_f32_16x16x32_bf16 v[224:227], v[132:135], v[40:43], v[224:227]
    v_and_b32_dpp v138, v16, v6 quad_perm:[2,2,2,2] row_mask:0xf bank_mask:0xf
    v_and_b32_dpp v139, v16, v7 quad_perm:[2,2,2,2] row_mask:0xf bank_mask:0xf
    v_mfma_f32_16x16x32_bf16 v[228:231], v[132:135], v[44:47], v[228:231]
    v_and_b32_dpp v140, v16, v4 quad_perm:[3,3,3,3] row_mask:0xf bank_mask:0xf
    v_and_b32_dpp v141, v16, v5 quad_perm:[3,3,3,3] row_mask:0xf bank_mask:0xf
    v_mfma_f32_16x16x32_bf16 v[224:227], v[136:139], v[48:51], v[224:227]
    v_and_b32_dpp v142, v16, v6 quad_perm:[3,3,3,3] row_mask:0xf bank_mask:0xf
    v_and_b32_dpp v143, v16, v7 quad_perm:[3,3,3,3] row_mask:0xf bank_mask:0xf
    v_mfma_f32_16x16x32_bf16 v[228:231], v[136:139], v[52:55], v[228:231]
    s_cmp_eq_u32 s3, 3
    v_mfma_f32_16x16x32_bf16 v[224:227], v[140:143], v[56:59], v[224:227]
    v_mfma_f32_16x16x32_bf16 v[228:231], v[140:143], v[60:63], v[228:231]
L_join:
    s_mov_b32 exec_lo, 0x00ff00ff
    s_mov_b32 exec_hi, 0xff00ff00
    s_nop 4
    ds_write_b128 v246, v[224:227] offset:13312
    ds_write_b128 v246, v[228:231] offset:13568
    s_mov_b64 exec, s[28:29]
    s_waitcnt lgkmcnt(0)
    s_barrier
    s_cbranch_scc1 L_done
    ds_read2st64_b32 v[16:17], v252 offset0:52 offset1:55
    ds_read2st64_b32 v[18:19], v252 offset0:58 offset1:61
    ds_read2st64_b32 v[20:21], v252 offset0:64 offset1:67
    ds_read2st64_b32 v[22:23], v252 offset0:70 offset1:73
    s_waitcnt lgkmcnt(0)
    v_pk_add_f32 v[16:17], v[16:17], v[18:19]
    v_pk_add_f32 v[20:21], v[20:21], v[22:23]
    v_pk_add_f32 v[16:17], v[16:17], v[20:21]
    v_add_f32 v9, v16, v17
    buffer_atomic_add_f32 v9, v253, s[48:51], s31 offen sc0
    v_add_f32 v8, v16, v17
    v_lshlrev_b32 v255, 16, v255
    s_mov_b32 s15, 200000
    s_waitcnt vmcnt(1)
L_g:
    v_mov_b32_dpp v16, v15 row_newbcast:15 row_mask:0xf bank_mask:0xf
    v_cvt_pk_bf16_f32 v15, v15, v15
    v_lshlrev_b32 v15, 16, v15
    v_cmp_neq_f32 vcc, 0x42400000, v16
    v_mul_f32 v17, 0xbfb8aa3b, v15
    v_exp_f32 v17, v17
    s_nop 0
    v_add_f32 v17, 1.0, v17
    v_rcp_f32 v17, v17
    s_nop 0
    v_mul_f32 v15, v15, v17
    s_mov_b64 s[6:7], vcc
    v_cvt_pk_bf16_f32 v15, v15, v15
    v_lshlrev_b32 v15, 16, v15
    s_waitcnt vmcnt(0)
    v_add_f32 v10, v8, v9
    v_cvt_pk_bf16_f32 v11, v10, v10
    v_lshlrev_b32 v11, 16, v11
    v_mov_b32_dpp v16, v10 row_newbcast:15 row_mask:0xf bank_mask:0xf
    v_mul_f32 v11, v11, v15
    v_cmp_eq_f32 vcc, 0x42400000, v16
    v_cvt_pk_bf16_f32 v11, v11, v11
    v_lshlrev_b32 v11, 16, v11
    s_and_b64 s[6:7], s[6:7], vcc
    v_add_f32 v11, v11, v255
    s_cbranch_scc1 L_gslow
L_gok:
    s_and_b64 exec, vcc, s[26:27]
    v_cvt_pk_bf16_f32 v11, v11, v11
    s_cbranch_scc0 L_done
    buffer_store_short v11, v254, s[68:71], 0 offen
L_done:
    s_endpgm
L_at:
    buffer_load_dwordx4 v[44:47], v248, s[56:59], s8 offen offset:128 nt
    s_addk_i32 s8, 5120
    buffer_load_dwordx4 v[48:51], v248, s[56:59], s8 offen offset:0 nt
    buffer_load_dwordx4 v[52:55], v248, s[56:59], s8 offen offset:128 nt
    s_addk_i32 s8, 5120
    buffer_load_dwordx4 v[56:59], v248, s[56:59], s8 offen offset:0 nt
    buffer_load_dwordx4 v[60:63], v248, s[56:59], s8 offen offset:128 nt
    s_waitcnt vmcnt(8)
    v_pk_add_f32 v[16:17], v[192:193], v[196:197]
    v_pk_add_f32 v[18:19], v[194:195], v[198:199]
    v_max3_u32 v28, v192, v193, v194
    v_max3_u32 v29, v195, v196, v197
    v_permlane32_swap_b32 v16, v18
    v_permlane32_swap_b32 v17, v19
    v_pk_add_f32 v[16:17], v[16:17], v[18:19]
    v_max3_u32 v28, v28, v198, v199
    v_max_u32 v28, v28, v29
    v_permlane16_swap_b32 v16, v17
    v_add_f32 v16, v16, v17
    v_cmp_eq_u32 vcc, -1, v28
    s_cbranch_vccnz L_bt
    v_add_f32_dpp v16, v16, v16 row_ror:8 row_mask:0xf bank_mask:0xf
    v_cvt_pk_bf16_f32 v16, v16, v16
    s_nop 1
    v_mov_b32_dpp v16, v16 row_shr:4 row_mask:0xf bank_mask:0x6
    s_nop 1
    v_and_b32_dpp v128, v16, v4 quad_perm:[0,0,0,0] row_mask:0xf bank_mask:0xf
    v_and_b32_dpp v129, v16, v5 quad_perm:[0,0,0,0] row_mask:0xf bank_mask:0xf
    v_and_b32_dpp v130, v16, v6 quad_perm:[0,0,0,0] row_mask:0xf bank_mask:0xf
    v_and_b32_dpp v131, v16, v7 quad_perm:[0,0,0,0] row_mask:0xf bank_mask:0xf
    v_and_b32_dpp v132, v16, v4 quad_perm:[1,1,1,1] row_mask:0xf bank_mask:0xf
    v_and_b32_dpp v133, v16, v5 quad_perm:[1,1,1,1] row_mask:0xf bank_mask:0xf
    v_and_b32_dpp v134, v16, v6 quad_perm:[1,1,1,1] row_mask:0xf bank_mask:0xf
    v_and_b32_dpp v135, v16, v7 quad_perm:[1,1,1,1] row_mask:0xf bank_mask:0xf
    v_and_b32_dpp v136, v16, v4 quad_perm:[2,2,2,2] row_mask:0xf bank_mask:0xf
    v_and_b32_dpp v137, v16, v5 quad_perm:[2,2,2,2] row_mask:0xf bank_mask:0xf
    v_and_b32_dpp v138, v16, v6 quad_perm:[2,2,2,2] row_mask:0xf bank_mask:0xf
    v_and_b32_dpp v139, v16, v7 quad_perm:[2,2,2,2] row_mask:0xf bank_mask:0xf
    v_and_b32_dpp v140, v16, v4 quad_perm:[3,3,3,3] row_mask:0xf bank_mask:0xf
    v_and_b32_dpp v141, v16, v5 quad_perm:[3,3,3,3] row_mask:0xf bank_mask:0xf
    v_and_b32_dpp v142, v16, v6 quad_perm:[3,3,3,3] row_mask:0xf bank_mask:0xf
    v_and_b32_dpp v143, v16, v7 quad_perm:[3,3,3,3] row_mask:0xf bank_mask:0xf
    s_cmp_eq_u32 s3, 3
    s_waitcnt vmcnt(7)
    v_mfma_f32_16x16x32_bf16 v[224:227], v[128:131], v[32:35], 0
    s_waitcnt vmcnt(6)
    v_mfma_f32_16x16x32_bf16 v[228:231], v[128:131], v[36:39], 0
    s_waitcnt vmcnt(5)
    v_mfma_f32_16x16x32_bf16 v[224:227], v[132:135], v[40:43], v[224:227]
    s_waitcnt vmcnt(4)
    v_mfma_f32_16x16x32_bf16 v[228:231], v[132:135], v[44:47], v[228:231]
    s_waitcnt vmcnt(3)
    v_mfma_f32_16x16x32_bf16 v[224:227], v[136:139], v[48:51], v[224:227]
    s_waitcnt vmcnt(2)
    v_mfma_f32_16x16x32_bf16 v[228:231], v[136:139], v[52:55], v[228:231]
    s_waitcnt vmcnt(1)
    v_mfma_f32_16x16x32_bf16 v[224:227], v[140:143], v[56:59], v[224:227]
    s_waitcnt vmcnt(0)
    v_mfma_f32_16x16x32_bf16 v[228:231], v[140:143], v[60:63], v[228:231]
    buffer_load_dword v15, v253, s[48:51], s30 offen sc1
    s_branch L_join
L_retry:
    s_sub_u32 s15, s15, 1
    s_cbranch_scc0 L_poll
    s_branch L_got
L_gslow:
    s_sub_u32 s15, s15, 1
    s_cbranch_scc1 L_gok
    buffer_load_dword v15, v253, s[48:51], s30 offen sc1
    s_waitcnt vmcnt(0)
    s_branch L_g
L_pubg:
    buffer_store_dwordx4 v[156:159], v31, s[48:51], s6 offen offset:1536 sc1
    s_branch L_pubd
L_pub1g:
    buffer_store_dwordx4 v[156:159], v31, s[48:51], s6 offen offset:1536 sc1
    s_branch L_pub1d
L_notile:
    s_cmp_eq_u32 s3, 0
    s_waitcnt lgkmcnt(0)
    s_barrier
    s_cbranch_scc1 L_pub
    s_endpgm
L_pad6:
    s_branch L_lq2
L_mlp2:
    s_mov_b64 s[64:65], s[36:37]
    s_mov_b32 s66, 256
    s_mov_b32 s67, 0x20000
    s_lshr_b32 s6, s13, 1
    s_lshl1_add_u32 s13, s6, s13
    s_lshl_b32 s13, s13, 7
    s_add_u32 s13, s13, s12
    s_mov_b32 s15, 200000
Lpoll4:
    s_mov_b32 s6, s13
    buffer_load_dwordx4 v[128:131], v249, s[48:51], s6 offen offset:256 sc1
    s_addk_i32 s6, 24576
    buffer_load_dwordx4 v[132:135], v249, s[48:51], s6 offen offset:256 sc1
    s_addk_i32 s6, 24576
    buffer_load_dwordx4 v[136:139], v249, s[48:51], s6 offen offset:256 sc1
    s_addk_i32 s6, 24576
    buffer_load_dwordx4 v[140:143], v249, s[48:51], s6 offen offset:256 sc1
    buffer_load_dword v29, off, s[64:67], 0 offset:4 sc1
    s_waitcnt vmcnt(0)
    v_cmp_gt_u32 vcc, 8, v29
    s_nop 1
    v_cndmask_b32 v29, 0, -1, vcc
    v_max3_u32 v28, v128, v129, v130
    v_max3_u32 v28, v28, v131, v132
    v_max3_u32 v28, v28, v133, v134
    v_max3_u32 v28, v28, v135, v136
    v_max3_u32 v28, v28, v137, v138
    v_max3_u32 v28, v28, v139, v140
    v_max3_u32 v28, v28, v141, v142
    v_max3_u32 v28, v28, v143, v29
    v_cmp_eq_u32 vcc, -1, v28
    s_cbranch_vccz Lpdone4
    s_sleep 4
    s_sub_u32 s15, s15, 1
    s_cbranch_scc0 Lpoll4
Lpdone4:
    ds_read_b128 v[64:67], v31 offset:20224
    ds_read_b128 v[68:71], v31 offset:21248
    ds_read_b128 v[72:75], v31 offset:22272
    ds_read_b128 v[76:79], v31 offset:23296
    ds_read_b128 v[80:83], v31 offset:24320
    ds_read_b128 v[84:87], v31 offset:25344
    ds_read_b128 v[88:91], v31 offset:26368
    ds_read_b128 v[92:95], v31 offset:27392
    v_pk_add_f32 v[128:129], v[128:129], v[132:133]
    v_pk_add_f32 v[132:133], v[136:137], v[140:141]
    v_pk_add_f32 v[130:131], v[130:131], v[134:135]
    v_pk_add_f32 v[134:135], v[138:139], v[142:143]
    s_nop 0
    v_permlane32_swap_b32 v128, v130
    v_permlane32_swap_b32 v129, v131
    v_pk_add_f32 v[128:129], v[128:129], v[130:131]
    s_nop 1
    v_permlane16_swap_b32 v128, v129
    v_add_f32 v128, v128, v129
    s_nop 1
    v_add_f32_dpp v128, v128, v128 row_ror:8 row_mask:0xf bank_mask:0xf
    v_permlane32_swap_b32 v132, v134
    v_permlane32_swap_b32 v133, v135
    v_pk_add_f32 v[132:133], v[132:133], v[134:135]
    s_nop 1
    v_permlane16_swap_b32 v132, v133
    v_add_f32 v132, v132, v133
    s_nop 1
    v_add_f32_dpp v132, v132, v132 row_ror:8 row_mask:0xf bank_mask:0xf
    v_cvt_pk_bf16_f32 v132, v128, v132
    v_lshlrev_b32 v128, 16, v132
    v_and_b32 v132, 0xffff0000, v132
    v_mul_f32 v129, 0xbfb8aa3b, v128
    v_exp_f32 v129, v129
    s_nop 0
    v_add_f32 v129, 1.0, v129
    v_rcp_f32 v129, v129
    s_nop 0
    v_mul_f32 v128, v128, v129
    v_cvt_pk_bf16_f32 v128, v128, v128
    v_lshlrev_b32 v128, 16, v128
    v_mul_f32 v128, v128, v132
    v_cvt_pk_bf16_f32 v128, v128, v128
    s_nop 1
    v_mov_b32_dpp v128, v128 row_shr:4 row_mask:0xf bank_mask:0x6
    s_nop 1
    v_and_b32_dpp v144, v128, v4 quad_perm:[0,0,0,0] row_mask:0xf bank_mask:0xf
    v_and_b32_dpp v145, v128, v5 quad_perm:[0,0,0,0] row_mask:0xf bank_mask:0xf
    v_and_b32_dpp v146, v128, v6 quad_perm:[0,0,0,0] row_mask:0xf bank_mask:0xf
    v_and_b32_dpp v147, v128, v7 quad_perm:[0,0,0,0] row_mask:0xf bank_mask:0xf
    v_and_b32_dpp v148, v128, v4 quad_perm:[1,1,1,1] row_mask:0xf bank_mask:0xf
    v_and_b32_dpp v149, v128, v5 quad_perm:[1,1,1,1] row_mask:0xf bank_mask:0xf
    v_and_b32_dpp v150, v128, v6 quad_perm:[1,1,1,1] row_mask:0xf bank_mask:0xf
    v_and_b32_dpp v151, v128, v7 quad_perm:[1,1,1,1] row_mask:0xf bank_mask:0xf
    v_and_b32_dpp v152, v128, v4 quad_perm:[2,2,2,2] row_mask:0xf bank_mask:0xf
    v_and_b32_dpp v153, v128, v5 quad_perm:[2,2,2,2] row_mask:0xf bank_mask:0xf
    v_and_b32_dpp v154, v128, v6 quad_perm:[2,2,2,2] row_mask:0xf bank_mask:0xf
    v_and_b32_dpp v155, v128, v7 quad_perm:[2,2,2,2] row_mask:0xf bank_mask:0xf
    v_and_b32_dpp v156, v128, v4 quad_perm:[3,3,3,3] row_mask:0xf bank_mask:0xf
    v_and_b32_dpp v157, v128, v5 quad_perm:[3,3,3,3] row_mask:0xf bank_mask:0xf
    v_and_b32_dpp v158, v128, v6 quad_perm:[3,3,3,3] row_mask:0xf bank_mask:0xf
    v_and_b32_dpp v159, v128, v7 quad_perm:[3,3,3,3] row_mask:0xf bank_mask:0xf
    v_mov_b32 v28, 0
    v_mov_b32 v29, 1.0
    ds_write_b32 v28, v29 offset:19968
    s_waitcnt lgkmcnt(0)
    v_mfma_f32_16x16x32_bf16 v[224:227], v[144:147], v[64:67], 0
    v_mfma_f32_16x16x32_bf16 v[228:231], v[144:147], v[68:71], 0
    v_mfma_f32_16x16x32_bf16 v[224:227], v[148:151], v[72:75], v[224:227]
    v_mfma_f32_16x16x32_bf16 v[228:231], v[148:151], v[76:79], v[228:231]
    v_mfma_f32_16x16x32_bf16 v[224:227], v[152:155], v[80:83], v[224:227]
    v_mfma_f32_16x16x32_bf16 v[228:231], v[152:155], v[84:87], v[228:231]
    v_mfma_f32_16x16x32_bf16 v[224:227], v[156:159], v[88:91], v[224:227]
    v_mfma_f32_16x16x32_bf16 v[228:231], v[156:159], v[92:95], v[228:231]
    s_nop 7
    v_permlane32_swap_b32 v224, v228
    v_permlane32_swap_b32 v225, v229
    v_permlane32_swap_b32 v226, v230
    v_permlane32_swap_b32 v227, v231
    v_add_f32_dpp v224, v228, v224 row_ror:8 row_mask:0xf bank_mask:0xf
    v_add_f32_dpp v225, v229, v225 row_ror:8 row_mask:0xf bank_mask:0xf
    v_add_f32_dpp v226, v230, v226 row_ror:8 row_mask:0xf bank_mask:0xf
    v_add_f32_dpp v227, v231, v227 row_ror:8 row_mask:0xf bank_mask:0xf
    s_mov_b32 exec_lo, 0x00ff00ff
    s_mov_b32 exec_hi, 0x00ff00ff
    ds_write_b128 v247, v[224:227] offset:19456
    s_mov_b64 exec, -1
    s_waitcnt lgkmcnt(0)
    s_barrier
    s_branch L_ea
L_end:
    s_endpgm
.section .rodata,"a"
.p2align 6
.amdhsa_kernel recurrent_scan__sliding_block_cached__glu_gated_swiglu__decode_kernel
  .amdhsa_next_free_vgpr 256
  .amdhsa_next_free_sgpr 102
  .amdhsa_accum_offset 256
  .amdhsa_group_segment_fixed_size 0
  .amdhsa_kernarg_size 96
  .amdhsa_user_sgpr_count 2
  .amdhsa_user_sgpr_kernarg_segment_ptr 1
  .amdhsa_system_sgpr_workgroup_id_x 1
  .amdhsa_float_denorm_mode_32 3
.end_amdhsa_kernel
```
